```python
import torch

def _softmax(x, axis=-1):
    return torch.softmax(x, dim=axis)
def _gelu(x):
    return torch.nn.functional.gelu(x, approximate="tanh")
def _silu(x):
    return torch.nn.functional.silu(x)
def _sigmoid(x):
    return torch.sigmoid(x)
def _layernorm(x, axis=-1, eps=1e-5):
    m = x.mean(dim=axis, keepdim=True)
    v = x.var(dim=axis, keepdim=True, unbiased=False)
    return (x - m) / torch.sqrt(v + eps)
def _scatter_add(tgt, idx, src, axis=0):
    return tgt.clone().index_add_(axis, idx, src)
def _segment_sum(src, seg, n):
    out = torch.zeros((n,) + src.shape[1:], dtype=src.dtype)
    return out.index_add_(0, seg, src)
def _pad(x, pw):
    flat = tuple(v for pair in reversed(pw) for v in pair)
    return torch.nn.functional.pad(x, flat)

kernel_name = 'standalone__mha_softmax__near_ridge'

def setup_inputs():

    _w = (lambda a: (lambda t: t.to(torch.bfloat16) if t.is_floating_point() else t)(torch.as_tensor(a)))
    B, H, Sq, Sk, D = 32, 32, 256, 512, 128
    return {
        "q": _w((lambda *s: torch.randn(*s, dtype=torch.bfloat16) * 0.8)(B, H, Sq, D)),
        "k": _w((lambda *s: torch.randn(*s, dtype=torch.bfloat16) * 0.8)(B, H, Sk, D)),
        "v": _w((lambda *s: torch.randn(*s, dtype=torch.bfloat16) * 0.05)(B, H, Sk, D)),
    }

def reference(q, k, v):
    scale = q.shape[-1] ** -0.5
    scores = torch.einsum("bhqd,bhkd->bhqk", q, k) * scale
    p = _softmax(scores, axis=-1)
    return torch.einsum("bhqk,bhkd->bhqd", p, v)
```

```asm
; @launch grid=(256,1,1) block=(256,1,1) lds=163840
.amdgcn_target "amdgcn-amd-amdhsa--gfx950"
.text
.globl standalone__mha_softmax__near_ridge_kernel
.p2align 8
.type standalone__mha_softmax__near_ridge_kernel,@function
standalone__mha_softmax__near_ridge_kernel:
    s_cmp_ge_u32 s2, 256
    s_cbranch_scc1 L_END
    s_load_dwordx8 s[40:47], s[0:1], 0
    s_getpc_b64 s[70:71]
    s_lshl_b32 s3, s2, 9
    s_and_b32 s3, s3, 0x7000
    v_lshl_add_u32 v6, v0, 4, s3
    global_load_dwordx4 v[160:163], v6, s[70:71]
    v_lshrrev_b32 v2, 6, v0
    v_and_b32 v1, 63, v0
    v_readfirstlane_b32 s37, v2
    v_lshrrev_b32 v3, 4, v1
    v_and_b32 v4, 15, v1
    v_lshlrev_b32 v5, 8, v3
    v_xor_b32 v2, v3, v4
    v_lshl_add_u32 v228, v2, 4, v5
    v_xor_b32 v229, 64, v228
    v_xor_b32 v230, 128, v228
    v_xor_b32 v231, 192, v228
    s_lshl_b32 s32, s37, 12
    s_mov_b32 s7, 0x20000
    s_mov_b32 s15, 0x20000
    s_lshl_b32 s36, s37, 15
    s_sub_u32 s6, 0x8000000, s36
    s_mov_b32 s14, 16384
    s_lshl_b32 s22, s2, 17
    s_lshl_b32 s26, s37, 10
    s_lshl2_add_u32 s35, s2, s37
    s_lshl_b32 s35, s35, 14
    s_add_u32 s26, s26, 98304
    s_mov_b32 s27, 0
    s_mov_b32 s24, s27
    s_mov_b32 m0, s32
    s_waitcnt lgkmcnt(0)
    s_add_u32 s4, s42, s36
    s_addc_u32 s5, s43, 0
    s_add_u32 s12, s40, s35
    s_addc_u32 s13, s41, 0
    buffer_load_dwordx4 v228, s[4:7], s22 offen nt lds
    buffer_load_dwordx4 v229, s[4:7], s22 offen offset:1024 nt lds
    buffer_load_dwordx4 v230, s[4:7], s22 offen offset:2048 nt lds
    buffer_load_dwordx4 v231, s[4:7], s22 offen offset:3072 nt lds
    s_add_u32 m0, s26, 0
    s_nop 0
    buffer_load_dwordx4 v228, s[12:15], s24 offen nt lds
    s_add_u32 m0, s26, 3072
    s_nop 0
    buffer_load_dwordx4 v229, s[12:15], s24 offen offset:1024 nt lds
    s_add_u32 m0, s26, 6144
    s_nop 0
    buffer_load_dwordx4 v230, s[12:15], s24 offen offset:2048 nt lds
    s_add_u32 m0, s26, 9216
    s_nop 0
    buffer_load_dwordx4 v231, s[12:15], s24 offen offset:3072 nt lds
    s_add_u32 m0, s26, 16384
    s_xor_b32 s24, s27, 4096
    buffer_load_dwordx4 v228, s[12:15], s24 offen nt lds
    s_add_u32 m0, s26, 19456
    s_nop 0
    buffer_load_dwordx4 v229, s[12:15], s24 offen offset:1024 nt lds
    s_add_u32 m0, s26, 22528
    s_nop 0
    buffer_load_dwordx4 v230, s[12:15], s24 offen offset:2048 nt lds
    s_add_u32 m0, s26, 25600
    s_nop 0
    buffer_load_dwordx4 v231, s[12:15], s24 offen offset:3072 nt lds
    s_add_u32 m0, s26, 32768
    s_xor_b32 s24, s27, 8192
    buffer_load_dwordx4 v228, s[12:15], s24 offen nt lds
    s_add_u32 m0, s26, 35840
    s_nop 0
    buffer_load_dwordx4 v229, s[12:15], s24 offen offset:1024 nt lds
    s_add_u32 m0, s26, 38912
    s_nop 0
    buffer_load_dwordx4 v230, s[12:15], s24 offen offset:2048 nt lds
    s_add_u32 m0, s26, 41984
    s_nop 0
    buffer_load_dwordx4 v231, s[12:15], s24 offen offset:3072 nt lds
    s_add_u32 m0, s26, 49152
    s_xor_b32 s24, s27, 12288
    buffer_load_dwordx4 v228, s[12:15], s24 offen nt lds
    s_add_u32 m0, s26, 52224
    s_nop 0
    buffer_load_dwordx4 v229, s[12:15], s24 offen offset:1024 nt lds
    s_add_u32 m0, s26, 55296
    s_nop 0
    buffer_load_dwordx4 v230, s[12:15], s24 offen offset:2048 nt lds
    s_add_u32 m0, s26, 58368
    s_nop 0
    buffer_load_dwordx4 v231, s[12:15], s24 offen offset:3072 nt lds
    v_lshlrev_b32 v232, 1, v3
    v_xor_b32 v232, v232, v4
    v_lshl_add_u32 v232, v232, 4, v5
    v_xor_b32 v233, 128, v232
    s_mov_b32 s11, 0x20000
    s_mov_b32 s19, 0x20000
    s_mov_b32 s10, s6
    s_mov_b32 s18, 0
    s_add_u32 s8, s44, s36
    s_addc_u32 s9, s45, 0
    s_add_u32 s16, s46, s35
    s_addc_u32 s17, s47, 0
    s_mov_b64 s[76:77], s[16:17]
    s_mov_b32 s78, 16384
    s_mov_b32 s79, 0x20000
    s_mov_b64 s[80:81], s[16:17]
    s_mov_b32 s82, 0
    s_mov_b32 s83, 0x20000
    s_add_u32 s30, s32, 32768
    s_mov_b32 s23, s22
    s_add_u32 s22, s22, 4096
    s_and_b32 s35, s22, 28672
    s_cselect_b32 s35, 0, 0x1ff8000
    s_add_u32 s22, s22, s35
    s_add_u32 m0, s30, 16384
    s_nop 0
    buffer_load_dwordx4 v232, s[8:11], s23 offen nt lds
    buffer_load_dwordx4 v233, s[8:11], s23 offen offset:1024 nt lds
    buffer_load_dwordx4 v232, s[8:11], s23 offen offset:2048 nt lds
    buffer_load_dwordx4 v233, s[8:11], s23 offen offset:3072 nt lds
    s_mov_b32 m0, s30
    s_nop 0
    buffer_load_dwordx4 v228, s[4:7], s22 offen nt lds
    buffer_load_dwordx4 v229, s[4:7], s22 offen offset:1024 nt lds
    buffer_load_dwordx4 v230, s[4:7], s22 offen offset:2048 nt lds
    buffer_load_dwordx4 v231, s[4:7], s22 offen offset:3072 nt lds
    s_mov_b32 s23, s22
    s_add_u32 s22, s22, 4096
    s_and_b32 s35, s22, 28672
    s_cselect_b32 s35, 0, 0x1ff8000
    s_add_u32 s22, s22, s35
    v_lshlrev_b32 v237, 4, v1
    v_add_u32 v237, s26, v237
    v_lshlrev_b32 v208, 4, v2
    v_lshl_add_u32 v208, v4, 8, v208
    v_xor_b32 v209, 64, v208
    v_xor_b32 v210, 128, v208
    v_xor_b32 v211, 192, v208
    v_and_b32 v5, 3, v1
    v_bfe_u32 v6, v1, 2, 2
    v_lshlrev_b32 v7, 12, v6
    v_lshl_add_u32 v7, v5, 8, v7
    v_add_u32 v7, s26, v7
    v_lshl_add_u32 v246, v2, 4, v7
    v_lshrrev_b32 v220, 1, v3
    v_xor_b32 v220, v220, v4
    v_lshl_add_u32 v220, v220, 4, v7
    v_and_b32 v7, 1, v3
    v_lshl_add_u32 v220, v7, 3, v220
    v_xor_b32 v221, 32, v220
    v_xor_b32 v222, 64, v220
    v_xor_b32 v223, 96, v220
    v_xor_b32 v224, 128, v220
    v_xor_b32 v225, 160, v220
    v_xor_b32 v226, 192, v220
    v_xor_b32 v227, 224, v220
    v_lshrrev_b32 v2, 2, v1
    v_lshlrev_b32 v212, 8, v2
    v_and_b32 v2, 7, v2
    v_lshl_add_u32 v212, v2, 5, v212
    v_lshl_add_u32 v212, v5, 3, v212
    v_xor_b32 v213, 32, v212
    v_xor_b32 v214, 64, v212
    v_xor_b32 v215, 96, v212
    v_xor_b32 v216, 128, v212
    v_xor_b32 v217, 160, v212
    v_xor_b32 v218, 192, v212
    v_xor_b32 v219, 224, v212
    v_mov_b32 v250, 0x30000
    v_mov_b32 v192, 0
    v_mov_b32 v193, 0
    v_mov_b32 v194, 0
    v_mov_b32 v195, 0
    v_mov_b32 v196, 0
    v_mov_b32 v197, 0
    v_mov_b32 v198, 0
    v_mov_b32 v199, 0
    v_mov_b32 v200, 0
    v_mov_b32 v201, 0
    v_mov_b32 v202, 0
    v_mov_b32 v203, 0
    v_mov_b32 v204, 0
    v_mov_b32 v205, 0
    v_mov_b32 v206, 0
    v_mov_b32 v207, 0
    ds_read_b128 a[128:131], v250
    ds_read_b128 a[132:135], v250
    ds_read_b128 a[136:139], v250
    ds_read_b128 a[140:143], v250
    ds_read_b128 a[144:147], v250
    ds_read_b128 a[148:151], v250
    ds_read_b128 a[152:155], v250
    ds_read_b128 a[156:159], v250
    v_mfma_f32_32x32x16_bf16 v[0:15], v[192:195], v[192:195], 0
    v_mfma_f32_32x32x16_bf16 v[16:31], v[192:195], v[192:195], 0
    v_mfma_f32_32x32x16_bf16 v[32:47], v[192:195], v[192:195], 0
    v_mfma_f32_32x32x16_bf16 v[48:63], v[192:195], v[192:195], 0
    v_mfma_f32_32x32x16_bf16 v[64:79], v[192:195], v[192:195], 0
    v_mfma_f32_32x32x16_bf16 v[80:95], v[192:195], v[192:195], 0
    v_mfma_f32_32x32x16_bf16 v[96:111], v[192:195], v[192:195], 0
    v_mfma_f32_32x32x16_bf16 v[112:127], v[192:195], v[192:195], 0
    v_mov_b32 v238, 0
    v_mov_b32 v239, 0
    v_mov_b32 v240, 0
    v_mov_b32 v241, 0
    v_mov_b32 v251, 0x3f803f80
    v_accvgpr_write_b32 a216, v251
    v_accvgpr_write_b32 a217, v251
    v_accvgpr_write_b32 a218, v251
    v_accvgpr_write_b32 a219, v251
    v_xor_b32 v247, 64, v246
    v_xor_b32 v248, 128, v246
    v_xor_b32 v249, 192, v246
    v_mov_b32 v234, v230
    v_mov_b32 v235, v231
    v_add_u32 v236, 8192, v237
    s_mov_b32 s20, 8
    s_mov_b32 s38, 32768
    s_mov_b32 s33, 0x3e0293ee
    s_mov_b32 s34, 0xbe0293ee
    s_mov_b32 s39, 0x47800000
    s_add_u32 s30, s32, 65536
    s_waitcnt vmcnt(16) lgkmcnt(0)
    s_barrier
    ds_read_b128 a[96:99], v208
    ds_read_b128 a[0:3], v246
    ds_read_b128 a[100:103], v209
    ds_read_b128 a[4:7], v247
    ds_read_b128 a[104:107], v210
    ds_read_b128 a[8:11], v248
    ds_read_b128 a[108:111], v211
    ds_read_b128 a[12:15], v249
    ds_read_b128 a[112:115], v208 offset:4096
    ds_read_b128 a[16:19], v246 offset:16384
    ds_read_b128 a[116:119], v209 offset:4096
    ds_read_b128 a[20:23], v247 offset:16384
    ds_read_b128 a[120:123], v210 offset:4096
    ds_read_b128 a[24:27], v248 offset:16384
    ds_read_b128 a[124:127], v211 offset:4096
    ds_read_b128 a[28:31], v249 offset:16384
    s_add_u32 m0, s30, 16384
    s_nop 0
    buffer_load_dwordx4 v232, s[8:11], s23 offen nt lds
    buffer_load_dwordx4 v233, s[8:11], s23 offen offset:1024 nt lds
    buffer_load_dwordx4 v232, s[8:11], s23 offen offset:2048 nt lds
    buffer_load_dwordx4 v233, s[8:11], s23 offen offset:3072 nt lds
    s_waitcnt lgkmcnt(0)
    v_mfma_f32_16x16x32_bf16 v[128:131], a[96:99], a[0:3], 0
    v_mfma_f32_16x16x32_bf16 v[128:131], a[100:103], a[4:7], v[128:131]
    v_mfma_f32_16x16x32_bf16 v[128:131], a[104:107], a[8:11], v[128:131]
    v_mfma_f32_16x16x32_bf16 v[128:131], a[108:111], a[12:15], v[128:131]
    v_mfma_f32_16x16x32_bf16 v[132:135], a[112:115], a[0:3], 0
    v_mfma_f32_16x16x32_bf16 v[132:135], a[116:119], a[4:7], v[132:135]
    v_mfma_f32_16x16x32_bf16 v[132:135], a[120:123], a[8:11], v[132:135]
    v_mfma_f32_16x16x32_bf16 v[132:135], a[124:127], a[12:15], v[132:135]
    s_mov_b32 m0, s30
    s_nop 0
    buffer_load_dwordx4 v228, s[4:7], s22 offen nt lds
    buffer_load_dwordx4 v229, s[4:7], s22 offen offset:1024 nt lds
    buffer_load_dwordx4 v230, s[4:7], s22 offen offset:2048 nt lds
    buffer_load_dwordx4 v231, s[4:7], s22 offen offset:3072 nt lds
    v_mfma_f32_16x16x32_bf16 v[136:139], a[96:99], a[16:19], 0
    v_mfma_f32_16x16x32_bf16 v[136:139], a[100:103], a[20:23], v[136:139]
    v_mfma_f32_16x16x32_bf16 v[136:139], a[104:107], a[24:27], v[136:139]
    v_mfma_f32_16x16x32_bf16 v[136:139], a[108:111], a[28:31], v[136:139]
    v_mfma_f32_16x16x32_bf16 v[140:143], a[112:115], a[16:19], 0
    v_mfma_f32_16x16x32_bf16 v[140:143], a[116:119], a[20:23], v[140:143]
    v_mfma_f32_16x16x32_bf16 v[140:143], a[120:123], a[24:27], v[140:143]
    v_mfma_f32_16x16x32_bf16 v[140:143], a[124:127], a[28:31], v[140:143]
    s_mov_b32 s23, s22
    s_add_u32 s22, s22, 4096
    s_and_b32 s35, s22, 28672
    s_cselect_b32 s35, 0, 0x1ff8000
    s_add_u32 s22, s22, s35
    s_waitcnt vmcnt(16)
    ds_read_b128 a[32:35], v246 offset:32768
    ds_read_b128 a[36:39], v247 offset:32768
    ds_read_b128 a[40:43], v248 offset:32768
    ds_read_b128 a[44:47], v249 offset:32768
    ds_read_b128 a[48:51], v246 offset:49152
    ds_read_b128 a[52:55], v247 offset:49152
    ds_read_b128 a[56:59], v248 offset:49152
    ds_read_b128 a[60:63], v249 offset:49152
    ds_read_b128 a[64:67], v208 offset:8192
    ds_read_b128 a[68:71], v209 offset:8192
    ds_read_b128 a[72:75], v210 offset:8192
    ds_read_b128 a[76:79], v211 offset:8192
    ds_read_b128 a[80:83], v208 offset:12288
    ds_read_b128 a[84:87], v209 offset:12288
    ds_read_b128 a[88:91], v210 offset:12288
    ds_read_b128 a[92:95], v211 offset:12288
    s_add_u32 s12, s12, 16777216
    s_addc_u32 s13, s13, 0
    s_mov_b32 m0, s26
    v_max3_f32 v242, v128, v129, v130
    v_max3_f32 v243, v136, v137, v138
    v_max3_f32 v242, v242, v131, v132
    v_max3_f32 v243, v243, v139, v140
    buffer_load_dwordx4 v228, s[12:15], s27 offen nt lds
    s_add_u32 m0, s26, 3072
    v_max3_f32 v242, v242, v133, v134
    v_max3_f32 v243, v243, v141, v142
    v_max_f32 v242, v242, v135
    v_max_f32 v243, v243, v143
    s_nop 1
    v_permlane32_swap_b32 v242, v243
    v_max_f32 v242, v242, v243
    v_mov_b32 v243, v242
    s_nop 1
    v_permlane16_swap_b32 v242, v243
    v_max_f32 v242, v242, v243
    v_mul_f32 v242, s34, v242
    v_mov_b32 v243, v242
    s_nop 1
    v_permlane32_swap_b32 v242, v243
    buffer_load_dwordx4 v229, s[12:15], s27 offen offset:1024 nt lds
    s_waitcnt lgkmcnt(8)
    v_mfma_f32_16x16x32_bf16 v[144:147], a[96:99], a[32:35], 0
    v_mfma_f32_16x16x32_bf16 v[144:147], a[100:103], a[36:39], v[144:147]
    v_mfma_f32_16x16x32_bf16 v[144:147], a[104:107], a[40:43], v[144:147]
    v_mfma_f32_16x16x32_bf16 v[144:147], a[108:111], a[44:47], v[144:147]
    v_mfma_f32_16x16x32_bf16 v[148:151], a[112:115], a[32:35], 0
    v_mfma_f32_16x16x32_bf16 v[148:151], a[116:119], a[36:39], v[148:151]
    v_mfma_f32_16x16x32_bf16 v[148:151], a[120:123], a[40:43], v[148:151]
    v_mfma_f32_16x16x32_bf16 v[148:151], a[124:127], a[44:47], v[148:151]
    v_mfma_f32_16x16x32_bf16 v[152:155], a[96:99], a[48:51], 0
    v_mfma_f32_16x16x32_bf16 v[152:155], a[100:103], a[52:55], v[152:155]
    v_mfma_f32_16x16x32_bf16 v[152:155], a[104:107], a[56:59], v[152:155]
    v_mfma_f32_16x16x32_bf16 v[152:155], a[108:111], a[60:63], v[152:155]
    v_mfma_f32_16x16x32_bf16 v[156:159], a[112:115], a[48:51], 0
    v_mfma_f32_16x16x32_bf16 v[156:159], a[116:119], a[52:55], v[156:159]
    v_mfma_f32_16x16x32_bf16 v[156:159], a[120:123], a[56:59], v[156:159]
    v_mfma_f32_16x16x32_bf16 v[156:159], a[124:127], a[60:63], v[156:159]
    s_mov_b32 s28, 2048
    s_xor_b32 s24, s27, 2048
    s_add_u32 s25, s26, 8192
    s_mov_b32 s29, 32768
    s_mov_b32 s30, s32
    v_add_u32 v208, 32768, v208
    v_add_u32 v209, 32768, v209
    v_add_u32 v210, 32768, v210
    v_add_u32 v211, 32768, v211
    v_add_u32 v212, 32768, v212
    v_add_u32 v213, 32768, v213
    v_add_u32 v214, 32768, v214
    v_add_u32 v215, 32768, v215
    v_add_u32 v216, 32768, v216
    v_add_u32 v217, 32768, v217
    v_add_u32 v218, 32768, v218
    v_add_u32 v219, 32768, v219
    v_max3_f32 v244, v144, v145, v146
    v_max3_f32 v245, v152, v153, v154
    v_max3_f32 v244, v244, v147, v148
    v_max3_f32 v245, v245, v155, v156
    v_max3_f32 v244, v244, v149, v150
    v_max3_f32 v245, v245, v157, v158
    v_max_f32 v244, v244, v151
    v_max_f32 v245, v245, v159
    s_nop 1
    v_permlane32_swap_b32 v244, v245
    v_max_f32 v244, v244, v245
    v_mov_b32 v245, v244
    s_nop 1
    v_permlane16_swap_b32 v244, v245
    v_max_f32 v244, v244, v245
    v_mul_f32 v244, s34, v244
    v_mov_b32 v245, v244
    s_nop 1
    v_permlane32_swap_b32 v244, v245
    s_waitcnt vmcnt(10)
    s_branch L_TOPN
    .p2align 6
L_TOPE:
    v_mfma_f32_16x16x32_bf16 v[0:3], a[128:131], v[192:195], v[0:3]
    s_waitcnt lgkmcnt(0)
    v_max3_f32 v242, v128, v129, v130
    v_max3_f32 v243, v136, v137, v138
    v_max3_f32 v242, v242, v131, v132
    v_max3_f32 v243, v243, v139, v140
    v_mfma_f32_16x16x32_bf16 v[184:187], a[216:219], v[204:207], 0
    v_max3_f32 v242, v242, v133, v134
    v_max3_f32 v243, v243, v141, v142
    v_max_f32 v242, v242, v135
    v_mfma_f32_16x16x32_bf16 v[4:7], a[132:135], v[192:195], v[4:7]
    v_max_f32 v243, v243, v143
    s_nop 1
    v_permlane32_swap_b32 v242, v243
    v_max_f32 v242, v242, v243
    v_mov_b32 v243, v242
    v_mfma_f32_16x16x32_bf16 v[8:11], a[136:139], v[192:195], v[8:11]
    s_barrier
    v_permlane16_swap_b32 v242, v243
    v_mfma_f32_16x16x32_bf16 v[12:15], a[140:143], v[192:195], v[12:15]
    ds_read_b128 a[96:99], v208
    v_max_f32 v242, v242, v243
    v_mul_f32 v242, s34, v242
    v_cmp_nge_f32 vcc, s39, v184
    v_mfma_f32_16x16x32_bf16 v[16:19], a[144:147], v[192:195], v[16:19]
    v_mov_b32 v243, v242
    s_nop 1
    v_permlane32_swap_b32 v242, v243
    v_fma_f32 v160, v128, s33, v242
    v_mfma_f32_16x16x32_bf16 v[20:23], a[148:151], v[192:195], v[20:23]
    s_mov_b32 m0, s30
    v_fma_f32 v161, v129, s33, v242
    v_fma_f32 v162, v130, s33, v242
    v_exp_f32 v176, v160
    v_mfma_f32_16x16x32_bf16 v[24:27], a[152:155], v[192:195], v[24:27]
    s_waitcnt vmcnt(7)
    buffer_load_dwordx4 v228, s[4:7], s22 offen nt lds
    v_mfma_f32_16x16x32_bf16 v[28:31], a[156:159], v[192:195], v[28:31]
    s_cbranch_vccnz L_TRE0
L_RTE0:
    ds_read_b128 a[100:103], v209
    v_fma_f32 v163, v131, s33, v242
    v_fma_f32 v164, v132, s33, v242
    v_add_f32 v241, v241, v184
    v_mfma_f32_16x16x32_bf16 v[32:35], a[128:131], v[196:199], v[32:35]
    s_add_u32 s12, s12, 16777216
    v_exp_f32 v177, v161
    v_fma_f32 v165, v133, s33, v242
    v_mfma_f32_16x16x32_bf16 v[36:39], a[132:135], v[196:199], v[36:39]
    s_addc_u32 s13, s13, 0
    v_fma_f32 v166, v134, s33, v242
    v_rcp_f32 v250, v238
    v_mfma_f32_16x16x32_bf16 v[40:43], a[136:139], v[196:199], v[40:43]
    s_cmp_ge_u32 s20, 24
    ds_read_b128 a[104:107], v210
    v_exp_f32 v178, v162
    v_fma_f32 v167, v135, s33, v242
    v_mfma_f32_16x16x32_bf16 v[44:47], a[140:143], v[196:199], v[44:47]
    s_cselect_b32 s35, 16777216, 0
    v_exp_f32 v179, v163
    v_rcp_f32 v252, v239
    v_mfma_f32_16x16x32_bf16 v[48:51], a[144:147], v[196:199], v[48:51]
    s_nop 0
    v_exp_f32 v180, v164
    v_cvt_pk_bf16_f32 v192, v176, v177
    v_mfma_f32_16x16x32_bf16 v[52:55], a[148:151], v[196:199], v[52:55]
    s_add_u32 s16, s16, s35
    ds_read_b128 a[108:111], v211
    v_exp_f32 v181, v165
    v_cvt_pk_bf16_f32 v193, v178, v179
    v_mfma_f32_16x16x32_bf16 v[56:59], a[152:155], v[196:199], v[56:59]
    s_addc_u32 s17, s17, 0
    v_exp_f32 v182, v166
    v_exp_f32 v183, v167
    v_mfma_f32_16x16x32_bf16 v[60:63], a[156:159], v[196:199], v[60:63]
    s_mov_b32 s28, 4096
    v_cvt_pk_bf16_f32 v194, v180, v181
    v_cvt_pk_bf16_f32 v195, v182, v183
    v_pk_mul_f32 v[0:1], v[0:1], v[250:251] op_sel_hi:[1,0]
    v_pk_mul_f32 v[2:3], v[2:3], v[250:251] op_sel_hi:[1,0]
    v_pk_mul_f32 v[4:5], v[4:5], v[250:251] op_sel_hi:[1,0]
    v_pk_mul_f32 v[6:7], v[6:7], v[250:251] op_sel_hi:[1,0]
    v_pk_mul_f32 v[8:9], v[8:9], v[250:251] op_sel_hi:[1,0]
    v_pk_mul_f32 v[10:11], v[10:11], v[250:251] op_sel_hi:[1,0]
    v_pk_mul_f32 v[12:13], v[12:13], v[250:251] op_sel_hi:[1,0]
    v_pk_mul_f32 v[14:15], v[14:15], v[250:251] op_sel_hi:[1,0]
    v_pk_mul_f32 v[16:17], v[16:17], v[250:251] op_sel_hi:[1,0]
    v_pk_mul_f32 v[18:19], v[18:19], v[250:251] op_sel_hi:[1,0]
    v_pk_mul_f32 v[20:21], v[20:21], v[250:251] op_sel_hi:[1,0]
    v_pk_mul_f32 v[22:23], v[22:23], v[250:251] op_sel_hi:[1,0]
    v_pk_mul_f32 v[24:25], v[24:25], v[250:251] op_sel_hi:[1,0]
    v_pk_mul_f32 v[26:27], v[26:27], v[250:251] op_sel_hi:[1,0]
    v_pk_mul_f32 v[28:29], v[28:29], v[250:251] op_sel_hi:[1,0]
    v_pk_mul_f32 v[30:31], v[30:31], v[250:251] op_sel_hi:[1,0]
    v_pk_mul_f32 v[32:33], v[32:33], v[252:253] op_sel_hi:[1,0]
    v_pk_mul_f32 v[34:35], v[34:35], v[252:253] op_sel_hi:[1,0]
    v_pk_mul_f32 v[36:37], v[36:37], v[252:253] op_sel_hi:[1,0]
    v_pk_mul_f32 v[38:39], v[38:39], v[252:253] op_sel_hi:[1,0]
    v_pk_mul_f32 v[40:41], v[40:41], v[252:253] op_sel_hi:[1,0]
    v_pk_mul_f32 v[42:43], v[42:43], v[252:253] op_sel_hi:[1,0]
    v_pk_mul_f32 v[44:45], v[44:45], v[252:253] op_sel_hi:[1,0]
    v_pk_mul_f32 v[46:47], v[46:47], v[252:253] op_sel_hi:[1,0]
    v_pk_mul_f32 v[48:49], v[48:49], v[252:253] op_sel_hi:[1,0]
    v_pk_mul_f32 v[50:51], v[50:51], v[252:253] op_sel_hi:[1,0]
    v_pk_mul_f32 v[52:53], v[52:53], v[252:253] op_sel_hi:[1,0]
    v_pk_mul_f32 v[54:55], v[54:55], v[252:253] op_sel_hi:[1,0]
    v_pk_mul_f32 v[56:57], v[56:57], v[252:253] op_sel_hi:[1,0]
    v_pk_mul_f32 v[58:59], v[58:59], v[252:253] op_sel_hi:[1,0]
    v_pk_mul_f32 v[60:61], v[60:61], v[252:253] op_sel_hi:[1,0]
    v_pk_mul_f32 v[62:63], v[62:63], v[252:253] op_sel_hi:[1,0]
    v_mfma_f32_16x16x32_bf16 v[128:131], a[64:67], a[0:3], 0
    s_xor_b32 s24, s27, 4096
    ds_read_b128 a[112:115], v208 offset:4096
    v_fma_f32 v168, v136, s33, v243
    v_fma_f32 v169, v137, s33, v243
    v_fma_f32 v170, v138, s33, v243
    v_cvt_pk_bf16_f32 v0, v0, v1
    v_mfma_f32_16x16x32_bf16 v[176:179], a[216:219], v[192:195], 0
    v_exp_f32 v184, v168
    v_fma_f32 v171, v139, s33, v243
    v_fma_f32 v172, v140, s33, v243
    v_cvt_pk_bf16_f32 v1, v2, v3
    v_mfma_f32_16x16x32_bf16 v[128:131], a[68:71], a[4:7], v[128:131]
    s_add_u32 m0, s30, 16384
    v_exp_f32 v185, v169
    v_fma_f32 v173, v141, s33, v243
    v_fma_f32 v174, v142, s33, v243
    v_cvt_pk_bf16_f32 v32, v32, v33
    v_mfma_f32_16x16x32_bf16 v[128:131], a[72:75], a[8:11], v[128:131]
    s_waitcnt vmcnt(7)
    ds_read_b128 a[116:119], v209 offset:4096
    buffer_load_dwordx4 v232, s[8:11], s23 offen nt lds
    v_cvt_pk_bf16_f32 v33, v34, v35
    v_mfma_f32_16x16x32_bf16 v[128:131], a[76:79], a[12:15], v[128:131]
    s_mov_b32 m0, s30
    ds_write_b64 v220, v[0:1]
    v_exp_f32 v186, v170
    v_fma_f32 v175, v143, s33, v243
    v_mfma_f32_16x16x32_bf16 v[132:135], a[80:83], a[0:3], 0
    s_waitcnt vmcnt(7)
    buffer_load_dwordx4 v229, s[4:7], s22 offen offset:1024 nt lds
    v_cvt_pk_bf16_f32 v4, v4, v5
    v_mov_b32 v238, v176
    v_mfma_f32_16x16x32_bf16 v[132:135], a[84:87], a[4:7], v[132:135]
    ds_write_b64 v220, v[32:33] offset:16384
    v_exp_f32 v187, v171
    v_cvt_pk_bf16_f32 v5, v6, v7
    v_mfma_f32_16x16x32_bf16 v[132:135], a[88:91], a[8:11], v[132:135]
    v_max3_f32 v244, v144, v145, v146
    v_max3_f32 v245, v152, v153, v154
    v_exp_f32 v188, v172
    v_cvt_pk_bf16_f32 v36, v36, v37
    v_mfma_f32_16x16x32_bf16 v[132:135], a[92:95], a[12:15], v[132:135]
    ds_write_b64 v221, v[4:5]
    v_max3_f32 v244, v244, v147, v148
    v_max3_f32 v245, v245, v155, v156
    v_cvt_pk_bf16_f32 v37, v38, v39
    v_mfma_f32_16x16x32_bf16 v[136:139], a[64:67], a[16:19], 0
    s_cmp_ge_u32 s20, 32
    v_cvt_pk_bf16_f32 v196, v184, v185
    v_max3_f32 v244, v244, v149, v150
    v_max3_f32 v245, v245, v157, v158
    v_cvt_pk_bf16_f32 v8, v8, v9
    v_mfma_f32_16x16x32_bf16 v[136:139], a[68:71], a[20:23], v[136:139]
    s_cselect_b32 s25, 0x28000, s26
    ds_write_b64 v221, v[36:37] offset:16384
    v_exp_f32 v189, v173
    v_max_f32 v244, v244, v151
    v_cvt_pk_bf16_f32 v9, v10, v11
    v_mfma_f32_16x16x32_bf16 v[136:139], a[72:75], a[24:27], v[136:139]
    s_cselect_b32 s14, 0, s14
    ds_read_b128 a[120:123], v210 offset:4096
    v_max_f32 v245, v245, v159
    v_cvt_pk_bf16_f32 v197, v186, v187
    s_nop 0
    v_permlane32_swap_b32 v244, v245
    v_cvt_pk_bf16_f32 v40, v40, v41
    v_mfma_f32_16x16x32_bf16 v[136:139], a[76:79], a[28:31], v[136:139]
    s_cselect_b32 s35, 16777216, 0
    ds_write_b64 v222, v[8:9]
    v_exp_f32 v190, v174
    v_cvt_pk_bf16_f32 v41, v42, v43
    v_mfma_f32_16x16x32_bf16 v[140:143], a[80:83], a[16:19], 0
    s_cselect_b32 s82, s78, 0
    v_max_f32 v244, v244, v245
    v_mov_b32 v245, v244
    v_exp_f32 v191, v175
    v_cvt_pk_bf16_f32 v12, v12, v13
    v_mfma_f32_16x16x32_bf16 v[140:143], a[84:87], a[20:23], v[140:143]
    s_sub_u32 s12, s12, s35
    ds_write_b64 v222, v[40:41] offset:16384
    v_permlane16_swap_b32 v244, v245
    v_cvt_pk_bf16_f32 v13, v14, v15
    v_mfma_f32_16x16x32_bf16 v[140:143], a[88:91], a[24:27], v[140:143]
    s_subb_u32 s13, s13, 0
    v_max_f32 v244, v244, v245
    v_cvt_pk_bf16_f32 v198, v188, v189
    v_mul_f32 v244, s34, v244
    v_mov_b32 v245, v244
    v_cvt_pk_bf16_f32 v44, v44, v45
    v_mfma_f32_16x16x32_bf16 v[140:143], a[92:95], a[28:31], v[140:143]
    s_add_u32 m0, s30, 16384
    ds_write_b64 v223, v[12:13]
    v_cvt_pk_bf16_f32 v199, v190, v191
    v_permlane32_swap_b32 v244, v245
    v_cvt_pk_bf16_f32 v45, v46, v47
    v_mfma_f32_16x16x32_bf16 v[64:67], a[128:131], v[200:203], v[64:67]
    s_waitcnt vmcnt(7)
    ds_read_b128 a[124:127], v211 offset:4096
    buffer_load_dwordx4 v233, s[8:11], s23 offen offset:1024 nt lds
    v_cvt_pk_bf16_f32 v16, v16, v17
    v_mfma_f32_16x16x32_bf16 v[184:187], a[216:219], v[196:199], 0
    ds_write_b64 v223, v[44:45] offset:16384
    v_fma_f32 v160, v144, s33, v244
    v_fma_f32 v161, v145, s33, v244
    v_cvt_pk_bf16_f32 v17, v18, v19
    v_mfma_f32_16x16x32_bf16 v[68:71], a[132:135], v[200:203], v[68:71]
    v_fma_f32 v162, v146, s33, v244
    v_exp_f32 v176, v160
    v_cvt_pk_bf16_f32 v48, v48, v49
    v_mfma_f32_16x16x32_bf16 v[72:75], a[136:139], v[200:203], v[72:75]
    v_fma_f32 v163, v147, s33, v244
    v_fma_f32 v164, v148, s33, v244
    v_exp_f32 v177, v161
    v_cvt_pk_bf16_f32 v49, v50, v51
    v_mfma_f32_16x16x32_bf16 v[76:79], a[140:143], v[200:203], v[76:79]
    s_mov_b32 m0, s30
    ds_write_b64 v224, v[16:17]
    v_fma_f32 v165, v149, s33, v244
    v_fma_f32 v166, v150, s33, v244
    v_mfma_f32_16x16x32_bf16 v[80:83], a[144:147], v[200:203], v[80:83]
    s_waitcnt vmcnt(7)
    buffer_load_dwordx4 v230, s[4:7], s22 offen offset:2048 nt lds
    v_cvt_pk_bf16_f32 v20, v20, v21
    v_mov_b32 v239, v184
    v_mfma_f32_16x16x32_bf16 v[84:87], a[148:151], v[200:203], v[84:87]
    ds_write_b64 v224, v[48:49] offset:16384
    v_exp_f32 v178, v162
    v_fma_f32 v167, v151, s33, v244
    v_cvt_pk_bf16_f32 v21, v22, v23
    v_mfma_f32_16x16x32_bf16 v[88:91], a[152:155], v[200:203], v[88:91]
    v_exp_f32 v179, v163
    v_exp_f32 v180, v164
    v_cvt_pk_bf16_f32 v52, v52, v53
    v_mfma_f32_16x16x32_bf16 v[92:95], a[156:159], v[200:203], v[92:95]
    ds_write_b64 v225, v[20:21]
    v_cvt_pk_bf16_f32 v200, v176, v177
    v_cvt_pk_bf16_f32 v53, v54, v55
    v_mfma_f32_16x16x32_bf16 v[96:99], a[128:131], v[204:207], v[96:99]
    s_mov_b64 s[80:81], s[16:17]
    ds_read_b64_tr_b16 a[128:129], v212 offset:16384
    v_exp_f32 v181, v165
    v_cvt_pk_bf16_f32 v201, v178, v179
    v_cvt_pk_bf16_f32 v24, v24, v25
    v_mfma_f32_16x16x32_bf16 v[100:103], a[132:135], v[204:207], v[100:103]
    s_mov_b32 s18, s78
    ds_read_b64_tr_b16 a[130:131], v212 offset:20480
    ds_write_b64 v225, v[52:53] offset:16384
    v_cvt_pk_bf16_f32 v25, v26, v27
    v_rcp_f32 v250, v240
    v_mfma_f32_16x16x32_bf16 v[104:107], a[136:139], v[204:207], v[104:107]
    ds_read_b64_tr_b16 a[132:133], v213 offset:16384
    v_exp_f32 v182, v166
    v_cvt_pk_bf16_f32 v56, v56, v57
    v_mfma_f32_16x16x32_bf16 v[108:111], a[140:143], v[204:207], v[108:111]
    ds_read_b64_tr_b16 a[134:135], v213 offset:20480
    ds_write_b64 v226, v[24:25]
    v_cvt_pk_bf16_f32 v57, v58, v59
    v_rcp_f32 v252, v241
    v_mfma_f32_16x16x32_bf16 v[112:115], a[144:147], v[204:207], v[112:115]
    ds_read_b64_tr_b16 a[136:137], v214 offset:16384
    v_exp_f32 v183, v167
    v_cvt_pk_bf16_f32 v202, v180, v181
    v_cvt_pk_bf16_f32 v28, v28, v29
    v_mfma_f32_16x16x32_bf16 v[116:119], a[148:151], v[204:207], v[116:119]
    s_add_u32 m0, s30, 16384
    ds_read_b64_tr_b16 a[138:139], v214 offset:20480
    ds_write_b64 v226, v[56:57] offset:16384
    v_cvt_pk_bf16_f32 v203, v182, v183
    v_cvt_pk_bf16_f32 v29, v30, v31
    v_mfma_f32_16x16x32_bf16 v[120:123], a[152:155], v[204:207], v[120:123]
    s_waitcnt vmcnt(7)
    ds_read_b64_tr_b16 a[140:141], v215 offset:16384
    buffer_load_dwordx4 v232, s[8:11], s23 offen offset:2048 nt lds
    v_cvt_pk_bf16_f32 v60, v60, v61
    v_mfma_f32_16x16x32_bf16 v[124:127], a[156:159], v[204:207], v[124:127]
    ds_read_b64_tr_b16 a[142:143], v215 offset:20480
    ds_write_b64 v227, v[28:29]
    v_cvt_pk_bf16_f32 v61, v62, v63
    v_pk_mul_f32 v[64:65], v[64:65], v[250:251] op_sel_hi:[1,0]
    v_pk_mul_f32 v[66:67], v[66:67], v[250:251] op_sel_hi:[1,0]
    v_pk_mul_f32 v[68:69], v[68:69], v[250:251] op_sel_hi:[1,0]
    v_pk_mul_f32 v[70:71], v[70:71], v[250:251] op_sel_hi:[1,0]
    v_pk_mul_f32 v[72:73], v[72:73], v[250:251] op_sel_hi:[1,0]
    v_pk_mul_f32 v[74:75], v[74:75], v[250:251] op_sel_hi:[1,0]
    v_pk_mul_f32 v[76:77], v[76:77], v[250:251] op_sel_hi:[1,0]
    v_pk_mul_f32 v[78:79], v[78:79], v[250:251] op_sel_hi:[1,0]
    v_pk_mul_f32 v[80:81], v[80:81], v[250:251] op_sel_hi:[1,0]
    v_pk_mul_f32 v[82:83], v[82:83], v[250:251] op_sel_hi:[1,0]
    v_pk_mul_f32 v[84:85], v[84:85], v[250:251] op_sel_hi:[1,0]
    v_pk_mul_f32 v[86:87], v[86:87], v[250:251] op_sel_hi:[1,0]
    v_pk_mul_f32 v[88:89], v[88:89], v[250:251] op_sel_hi:[1,0]
    v_pk_mul_f32 v[90:91], v[90:91], v[250:251] op_sel_hi:[1,0]
    v_pk_mul_f32 v[92:93], v[92:93], v[250:251] op_sel_hi:[1,0]
    v_pk_mul_f32 v[94:95], v[94:95], v[250:251] op_sel_hi:[1,0]
    v_pk_mul_f32 v[96:97], v[96:97], v[252:253] op_sel_hi:[1,0]
    v_pk_mul_f32 v[98:99], v[98:99], v[252:253] op_sel_hi:[1,0]
    v_pk_mul_f32 v[100:101], v[100:101], v[252:253] op_sel_hi:[1,0]
    v_pk_mul_f32 v[102:103], v[102:103], v[252:253] op_sel_hi:[1,0]
    v_pk_mul_f32 v[104:105], v[104:105], v[252:253] op_sel_hi:[1,0]
    v_pk_mul_f32 v[106:107], v[106:107], v[252:253] op_sel_hi:[1,0]
    v_pk_mul_f32 v[108:109], v[108:109], v[252:253] op_sel_hi:[1,0]
    v_pk_mul_f32 v[110:111], v[110:111], v[252:253] op_sel_hi:[1,0]
    v_pk_mul_f32 v[112:113], v[112:113], v[252:253] op_sel_hi:[1,0]
    v_pk_mul_f32 v[114:115], v[114:115], v[252:253] op_sel_hi:[1,0]
    v_pk_mul_f32 v[116:117], v[116:117], v[252:253] op_sel_hi:[1,0]
    v_pk_mul_f32 v[118:119], v[118:119], v[252:253] op_sel_hi:[1,0]
    v_pk_mul_f32 v[120:121], v[120:121], v[252:253] op_sel_hi:[1,0]
    v_pk_mul_f32 v[122:123], v[122:123], v[252:253] op_sel_hi:[1,0]
    v_pk_mul_f32 v[124:125], v[124:125], v[252:253] op_sel_hi:[1,0]
    v_pk_mul_f32 v[126:127], v[126:127], v[252:253] op_sel_hi:[1,0]
    v_mfma_f32_16x16x32_bf16 v[144:147], a[64:67], a[32:35], 0
    ds_read_b64_tr_b16 a[144:145], v216 offset:16384
    v_fma_f32 v168, v152, s33, v245
    v_fma_f32 v169, v153, s33, v245
    v_cvt_pk_bf16_f32 v64, v64, v65
    v_mfma_f32_16x16x32_bf16 v[176:179], a[216:219], v[200:203], 0
    ds_read_b64_tr_b16 a[146:147], v216 offset:20480
    ds_write_b64 v227, v[60:61] offset:16384
    v_fma_f32 v170, v154, s33, v245
    v_cvt_pk_bf16_f32 v65, v66, v67
    v_mfma_f32_16x16x32_bf16 v[144:147], a[68:71], a[36:39], v[144:147]
    s_mov_b32 m0, s30
    ds_read_b64_tr_b16 a[148:149], v217 offset:16384
    v_exp_f32 v184, v168
    v_cvt_pk_bf16_f32 v96, v96, v97
    v_mfma_f32_16x16x32_bf16 v[144:147], a[72:75], a[40:43], v[144:147]
    s_waitcnt vmcnt(7)
    ds_read_b128 a[192:195], v237
    buffer_load_dwordx4 v231, s[4:7], s22 offen offset:3072 nt lds
    v_cvt_pk_bf16_f32 v97, v98, v99
    v_mfma_f32_16x16x32_bf16 v[144:147], a[76:79], a[44:47], v[144:147]
    ds_read_b64_tr_b16 a[150:151], v217 offset:20480
    ds_write_b64 v220, v[64:65] offset:32768
    v_fma_f32 v171, v155, s33, v245
    v_fma_f32 v172, v156, s33, v245
    v_mfma_f32_16x16x32_bf16 v[148:151], a[80:83], a[32:35], 0
    ds_read_b64_tr_b16 a[152:153], v218 offset:16384
    v_exp_f32 v185, v169
    v_cvt_pk_bf16_f32 v68, v68, v69
    v_mov_b32 v240, v176
    v_mfma_f32_16x16x32_bf16 v[148:151], a[84:87], a[36:39], v[148:151]
    ds_read_b64_tr_b16 a[154:155], v218 offset:20480
    ds_write_b64 v220, v[96:97] offset:49152
    v_cvt_pk_bf16_f32 v69, v70, v71
    v_mfma_f32_16x16x32_bf16 v[148:151], a[88:91], a[40:43], v[148:151]
    ds_read_b64_tr_b16 a[156:157], v219 offset:16384
    v_fma_f32 v173, v157, s33, v245
    v_fma_f32 v174, v158, s33, v245
    v_cvt_pk_bf16_f32 v100, v100, v101
    v_mfma_f32_16x16x32_bf16 v[148:151], a[92:95], a[44:47], v[148:151]
    ds_write_b64 v221, v[68:69] offset:32768
    ds_read_b128 a[196:199], v237 offset:4096
    v_cvt_pk_bf16_f32 v101, v102, v103
    v_mfma_f32_16x16x32_bf16 v[152:155], a[64:67], a[48:51], 0
    s_mov_b32 s36, s22
    ds_read_b64_tr_b16 a[158:159], v219 offset:20480
    v_exp_f32 v186, v170
    v_fma_f32 v175, v159, s33, v245
    v_cvt_pk_bf16_f32 v72, v72, v73
    v_mfma_f32_16x16x32_bf16 v[152:155], a[68:71], a[52:55], v[152:155]
    s_add_u32 s22, s22, 4096
    ds_write_b64 v221, v[100:101] offset:49152
    v_exp_f32 v187, v171
    v_cvt_pk_bf16_f32 v73, v74, v75
    v_mfma_f32_16x16x32_bf16 v[152:155], a[72:75], a[56:59], v[152:155]
    s_and_b32 s35, s22, 28672
    ds_read_b128 a[200:203], v237 offset:8192
    v_exp_f32 v188, v172
    v_cvt_pk_bf16_f32 v104, v104, v105
    v_mfma_f32_16x16x32_bf16 v[152:155], a[76:79], a[60:63], v[152:155]
    s_cselect_b32 s35, 0, 0x1ff8000
    ds_write_b64 v222, v[72:73] offset:32768
    v_cvt_pk_bf16_f32 v204, v184, v185
    v_cvt_pk_bf16_f32 v105, v106, v107
    v_mfma_f32_16x16x32_bf16 v[156:159], a[80:83], a[48:51], 0
    s_add_u32 s22, s22, s35
    v_exp_f32 v189, v173
    v_cvt_pk_bf16_f32 v205, v186, v187
    v_cvt_pk_bf16_f32 v76, v76, v77
    v_mfma_f32_16x16x32_bf16 v[156:159], a[84:87], a[52:55], v[156:159]
    ds_write_b64 v222, v[104:105] offset:49152
    v_exp_f32 v190, v174
    v_cvt_pk_bf16_f32 v77, v78, v79
    v_mfma_f32_16x16x32_bf16 v[156:159], a[88:91], a[56:59], v[156:159]
    s_cmp_eq_u32 s29, 65536
    ds_read_b128 a[204:207], v237 offset:12288
    v_exp_f32 v191, v175
    v_cvt_pk_bf16_f32 v206, v188, v189
    v_cvt_pk_bf16_f32 v108, v108, v109
    v_mfma_f32_16x16x32_bf16 v[156:159], a[92:95], a[60:63], v[156:159]
    s_waitcnt lgkmcnt(9)
    s_cselect_b32 s31, 0xffff0000, s38
    ds_write_b64 v223, v[76:77] offset:32768
    v_cvt_pk_bf16_f32 v207, v190, v191
    v_cvt_pk_bf16_f32 v109, v110, v111
    v_mfma_f32_16x16x32_bf16 v[0:3], a[128:131], v[192:195], 0
    v_fma_f32 v160, v128, s33, v242
    v_fma_f32 v161, v129, s33, v242
    v_fma_f32 v162, v130, s33, v242
    v_cvt_pk_bf16_f32 v80, v80, v81
    v_mfma_f32_16x16x32_bf16 v[184:187], a[216:219], v[204:207], 0
    ds_write_b64 v223, v[108:109] offset:49152
    v_exp_f32 v176, v160
    v_cvt_pk_bf16_f32 v81, v82, v83
    v_mfma_f32_16x16x32_bf16 v[4:7], a[132:135], v[192:195], 0
    s_add_u32 m0, s30, 16384
    v_fma_f32 v163, v131, s33, v242
    v_fma_f32 v164, v132, s33, v242
    v_cvt_pk_bf16_f32 v112, v112, v113
    v_mfma_f32_16x16x32_bf16 v[8:11], a[136:139], v[192:195], 0
    s_waitcnt vmcnt(7)
    buffer_load_dwordx4 v233, s[8:11], s23 offen offset:3072 nt lds
    v_cvt_pk_bf16_f32 v113, v114, v115
    v_mfma_f32_16x16x32_bf16 v[12:15], a[140:143], v[192:195], 0
    ds_write_b64 v224, v[80:81] offset:32768
    v_exp_f32 v177, v161
    v_fma_f32 v165, v133, s33, v242
    v_mfma_f32_16x16x32_bf16 v[16:19], a[144:147], v[192:195], 0
    ds_read_b128 a[64:67], v208 offset:8192
    v_fma_f32 v166, v134, s33, v242
    v_cvt_pk_bf16_f32 v84, v84, v85
    v_mov_b32 v241, v184
    v_mfma_f32_16x16x32_bf16 v[20:23], a[148:151], v[192:195], 0
    ds_write_b64 v224, v[112:113] offset:49152
    v_cvt_pk_bf16_f32 v85, v86, v87
    v_mfma_f32_16x16x32_bf16 v[24:27], a[152:155], v[192:195], 0
    s_waitcnt lgkmcnt(6)
    v_exp_f32 v178, v162
    v_fma_f32 v167, v135, s33, v242
    v_cvt_pk_bf16_f32 v116, v116, v117
    v_mfma_f32_16x16x32_bf16 v[28:31], a[156:159], v[192:195], 0
    ds_write_b64 v225, v[84:85] offset:32768
    v_exp_f32 v179, v163
    v_cvt_pk_bf16_f32 v117, v118, v119
    v_mfma_f32_16x16x32_bf16 v[32:35], a[128:131], v[196:199], 0
    v_exp_f32 v180, v164
    v_cvt_pk_bf16_f32 v192, v176, v177
    v_cvt_pk_bf16_f32 v88, v88, v89
    v_mfma_f32_16x16x32_bf16 v[36:39], a[132:135], v[196:199], 0
    ds_write_b64 v225, v[116:117] offset:49152
    v_exp_f32 v181, v165
    v_cvt_pk_bf16_f32 v89, v90, v91
    v_mfma_f32_16x16x32_bf16 v[40:43], a[136:139], v[196:199], 0
    ds_read_b128 a[68:71], v209 offset:8192
    v_cvt_pk_bf16_f32 v193, v178, v179
    v_cvt_pk_bf16_f32 v120, v120, v121
    v_mfma_f32_16x16x32_bf16 v[44:47], a[140:143], v[196:199], 0
    ds_write_b64 v226, v[88:89] offset:32768
    v_exp_f32 v182, v166
    v_cvt_pk_bf16_f32 v121, v122, v123
    v_mfma_f32_16x16x32_bf16 v[48:51], a[144:147], v[196:199], 0
    v_exp_f32 v183, v167
    v_cvt_pk_bf16_f32 v92, v92, v93
    v_mfma_f32_16x16x32_bf16 v[52:55], a[148:151], v[196:199], 0
    s_add_u32 m0, s25, 0
    ds_write_b64 v226, v[120:121] offset:49152
    v_cvt_pk_bf16_f32 v194, v180, v181
    v_cvt_pk_bf16_f32 v195, v182, v183
    v_cvt_pk_bf16_f32 v93, v94, v95
    v_mfma_f32_16x16x32_bf16 v[56:59], a[152:155], v[196:199], 0
    s_waitcnt vmcnt(7)
    buffer_load_dwordx4 v228, s[12:15], s27 offen nt lds
    v_cvt_pk_bf16_f32 v124, v124, v125
    v_mfma_f32_16x16x32_bf16 v[60:63], a[156:159], v[196:199], 0
    ds_write_b64 v227, v[92:93] offset:32768
    v_cvt_pk_bf16_f32 v125, v126, v127
    v_mfma_f32_16x16x32_bf16 v[128:131], a[96:99], a[0:3], 0
    v_fma_f32 v168, v136, s33, v243
    v_fma_f32 v169, v137, s33, v243
    v_fma_f32 v170, v138, s33, v243
    v_mfma_f32_16x16x32_bf16 v[176:179], a[216:219], v[192:195], 0
    ds_write_b64 v227, v[124:125] offset:49152
    v_mfma_f32_16x16x32_bf16 v[128:131], a[100:103], a[4:7], v[128:131]
    ds_read_b128 a[72:75], v210 offset:8192
    v_exp_f32 v184, v168
    v_mfma_f32_16x16x32_bf16 v[128:131], a[104:107], a[8:11], v[128:131]
    v_fma_f32 v171, v139, s33, v243
    v_add_u32 v236, 16384, v237
    v_mfma_f32_16x16x32_bf16 v[128:131], a[108:111], a[12:15], v[128:131]
    v_fma_f32 v172, v140, s33, v243
    v_cmp_nge_f32 vcc, s39, v176
    v_mfma_f32_16x16x32_bf16 v[132:135], a[112:115], a[0:3], 0
    v_exp_f32 v185, v169
    v_fma_f32 v173, v141, s33, v243
    v_mfma_f32_16x16x32_bf16 v[132:135], a[116:119], a[4:7], v[132:135]
    s_cbranch_vccnz L_TRE5
L_RTE5:
    ds_read_b128 a[76:79], v211 offset:8192
    v_fma_f32 v174, v142, s33, v243
    v_add_f32 v238, v238, v176
    v_mfma_f32_16x16x32_bf16 v[132:135], a[120:123], a[8:11], v[132:135]
    v_exp_f32 v186, v170
    v_mfma_f32_16x16x32_bf16 v[132:135], a[124:127], a[12:15], v[132:135]
    v_fma_f32 v175, v143, s33, v243
    v_exp_f32 v187, v171
    v_mfma_f32_16x16x32_bf16 v[136:139], a[96:99], a[16:19], 0
    s_cmp_lt_u32 s20, 32
    ds_read_b128 a[80:83], v208 offset:12288
    v_exp_f32 v188, v172
    v_mfma_f32_16x16x32_bf16 v[136:139], a[100:103], a[20:23], v[136:139]
    s_cbranch_scc1 L_DEFE
L_DEFRETE:
    v_cvt_pk_bf16_f32 v196, v184, v185
    v_add_u32 v208, s31, v208
    v_mfma_f32_16x16x32_bf16 v[136:139], a[104:107], a[24:27], v[136:139]
    v_exp_f32 v189, v173
    v_cvt_pk_bf16_f32 v197, v186, v187
    v_mfma_f32_16x16x32_bf16 v[136:139], a[108:111], a[28:31], v[136:139]
    ds_read_b128 a[84:87], v209 offset:12288
    v_exp_f32 v190, v174
    v_mfma_f32_16x16x32_bf16 v[140:143], a[112:115], a[16:19], 0
    ds_read_b128 a[208:211], v237 offset:16384
    v_add_u32 v209, s31, v209
    v_mfma_f32_16x16x32_bf16 v[140:143], a[116:119], a[20:23], v[140:143]
    s_add_u32 m0, s25, 3072
    v_exp_f32 v191, v175
    v_mfma_f32_16x16x32_bf16 v[140:143], a[120:123], a[24:27], v[140:143]
    s_waitcnt vmcnt(7)
    buffer_load_dwordx4 v229, s[12:15], s27 offen offset:1024 nt lds
    v_mfma_f32_16x16x32_bf16 v[140:143], a[124:127], a[28:31], v[140:143]
    v_cvt_pk_bf16_f32 v198, v188, v189
    v_cvt_pk_bf16_f32 v199, v190, v191
    v_mfma_f32_16x16x32_bf16 v[64:67], a[128:131], v[200:203], 0
    v_fma_f32 v160, v144, s33, v244
    v_fma_f32 v161, v145, s33, v244
    v_fma_f32 v162, v146, s33, v244
    v_mfma_f32_16x16x32_bf16 v[184:187], a[216:219], v[196:199], 0
    ds_read_b128 a[88:91], v210 offset:12288
    v_exp_f32 v176, v160
    v_mfma_f32_16x16x32_bf16 v[68:71], a[132:135], v[200:203], 0
    v_fma_f32 v163, v147, s33, v244
    v_add_u32 v210, s31, v210
    v_mfma_f32_16x16x32_bf16 v[72:75], a[136:139], v[200:203], 0
    v_fma_f32 v164, v148, s33, v244
    v_exp_f32 v177, v161
    v_mfma_f32_16x16x32_bf16 v[76:79], a[140:143], v[200:203], 0
    ds_read_b128 a[92:95], v211 offset:12288
    v_fma_f32 v165, v149, s33, v244
    v_cmp_nge_f32 vcc, s39, v184
    v_mfma_f32_16x16x32_bf16 v[80:83], a[144:147], v[200:203], 0
    v_fma_f32 v166, v150, s33, v244
    v_add_u32 v211, s31, v211
    v_mfma_f32_16x16x32_bf16 v[84:87], a[148:151], v[200:203], 0
    s_cbranch_vccnz L_TRE6
L_RTE6:
    v_exp_f32 v178, v162
    v_add_f32 v239, v239, v184
    v_mfma_f32_16x16x32_bf16 v[88:91], a[152:155], v[200:203], 0
    v_fma_f32 v167, v151, s33, v244
    v_exp_f32 v179, v163
    v_mfma_f32_16x16x32_bf16 v[92:95], a[156:159], v[200:203], 0
    v_exp_f32 v180, v164
    v_mfma_f32_16x16x32_bf16 v[96:99], a[128:131], v[204:207], 0
    s_add_u32 s20, s20, 1
    ds_read_b64_tr_b16 a[128:129], v212 offset:24576
    v_cvt_pk_bf16_f32 v200, v176, v177
    v_exp_f32 v181, v165
    v_mfma_f32_16x16x32_bf16 v[100:103], a[132:135], v[204:207], 0
    ds_read_b64_tr_b16 a[130:131], v212 offset:28672
    v_cvt_pk_bf16_f32 v201, v178, v179
    v_mfma_f32_16x16x32_bf16 v[104:107], a[136:139], v[204:207], 0
    ds_read_b64_tr_b16 a[132:133], v213 offset:24576
    v_add_u32 v212, s31, v212
    v_mfma_f32_16x16x32_bf16 v[108:111], a[140:143], v[204:207], 0
    ds_read_b64_tr_b16 a[134:135], v213 offset:28672
    v_exp_f32 v182, v166
    v_mfma_f32_16x16x32_bf16 v[112:115], a[144:147], v[204:207], 0
    ds_read_b64_tr_b16 a[136:137], v214 offset:24576
    v_add_u32 v213, s31, v213
    v_mfma_f32_16x16x32_bf16 v[116:119], a[148:151], v[204:207], 0
    s_add_u32 m0, s25, 6144
    ds_read_b64_tr_b16 a[138:139], v214 offset:28672
    v_exp_f32 v183, v167
    v_cvt_pk_bf16_f32 v202, v180, v181
    v_mfma_f32_16x16x32_bf16 v[120:123], a[152:155], v[204:207], 0
    s_waitcnt vmcnt(7)
    buffer_load_dwordx4 v230, s[12:15], s27 offen offset:2048 nt lds
    v_add_u32 v214, s31, v214
    v_mfma_f32_16x16x32_bf16 v[124:127], a[156:159], v[204:207], 0
    ds_read_b64_tr_b16 a[140:141], v215 offset:24576
    v_cvt_pk_bf16_f32 v203, v182, v183
    v_mfma_f32_16x16x32_bf16 v[144:147], a[96:99], a[32:35], 0
    ds_read_b64_tr_b16 a[142:143], v215 offset:28672
    v_fma_f32 v168, v152, s33, v245
    v_fma_f32 v169, v153, s33, v245
    v_mfma_f32_16x16x32_bf16 v[176:179], a[216:219], v[200:203], 0
    ds_read_b64_tr_b16 a[144:145], v216 offset:24576
    v_fma_f32 v170, v154, s33, v245
    v_add_u32 v215, s31, v215
    v_mfma_f32_16x16x32_bf16 v[144:147], a[100:103], a[36:39], v[144:147]
    ds_read_b64_tr_b16 a[146:147], v216 offset:28672
    v_exp_f32 v184, v168
    v_mfma_f32_16x16x32_bf16 v[144:147], a[104:107], a[40:43], v[144:147]
    ds_read_b64_tr_b16 a[148:149], v217 offset:24576
    v_add_u32 v216, s31, v216
    v_mfma_f32_16x16x32_bf16 v[144:147], a[108:111], a[44:47], v[144:147]
    ds_read_b64_tr_b16 a[150:151], v217 offset:28672
    v_fma_f32 v171, v155, s33, v245
    v_cmp_nge_f32 vcc, s39, v176
    v_mfma_f32_16x16x32_bf16 v[148:151], a[112:115], a[32:35], 0
    ds_read_b64_tr_b16 a[152:153], v218 offset:24576
    v_fma_f32 v172, v156, s33, v245
    v_add_u32 v217, s31, v217
    v_mfma_f32_16x16x32_bf16 v[148:151], a[116:119], a[36:39], v[148:151]
    s_cbranch_vccnz L_TRE7
L_RTE7:
    ds_read_b64_tr_b16 a[154:155], v218 offset:28672
    v_add_f32 v240, v240, v176
    v_mfma_f32_16x16x32_bf16 v[148:151], a[120:123], a[40:43], v[148:151]
    ds_read_b64_tr_b16 a[156:157], v219 offset:24576
    v_exp_f32 v185, v169
    v_add_u32 v218, s31, v218
    v_mfma_f32_16x16x32_bf16 v[148:151], a[124:127], a[44:47], v[148:151]
    s_add_u32 s30, s29, s32
    ds_read_b64_tr_b16 a[158:159], v219 offset:28672
    v_fma_f32 v173, v157, s33, v245
    v_mfma_f32_16x16x32_bf16 v[152:155], a[96:99], a[48:51], 0
    s_mov_b32 s23, s36
    v_fma_f32 v174, v158, s33, v245
    v_exp_f32 v186, v170
    v_add_u32 v219, s31, v219
    v_mfma_f32_16x16x32_bf16 v[152:155], a[100:103], a[52:55], v[152:155]
    s_add_u32 s29, s29, s31
    v_fma_f32 v175, v159, s33, v245
    v_mfma_f32_16x16x32_bf16 v[152:155], a[104:107], a[56:59], v[152:155]
    v_exp_f32 v187, v171
    v_exp_f32 v188, v172
    v_mfma_f32_16x16x32_bf16 v[152:155], a[108:111], a[60:63], v[152:155]
    s_add_u32 m0, s25, 9216
    v_cvt_pk_bf16_f32 v204, v184, v185
    v_exp_f32 v189, v173
    v_mfma_f32_16x16x32_bf16 v[156:159], a[112:115], a[48:51], 0
    s_waitcnt vmcnt(7) lgkmcnt(5)
    buffer_load_dwordx4 v231, s[12:15], s27 offen offset:3072 nt lds
    v_mfma_f32_16x16x32_bf16 v[156:159], a[116:119], a[52:55], v[156:159]
    s_add_u32 s25, s25, 16384
    v_cvt_pk_bf16_f32 v205, v186, v187
    v_exp_f32 v190, v174
    v_mfma_f32_16x16x32_bf16 v[156:159], a[120:123], a[56:59], v[156:159]
    s_waitcnt vmcnt(12)
    v_exp_f32 v191, v175
    v_mfma_f32_16x16x32_bf16 v[156:159], a[124:127], a[60:63], v[156:159]
    s_cmp_ge_u32 s20, 32
    v_cvt_pk_bf16_f32 v206, v188, v189
    v_cvt_pk_bf16_f32 v207, v190, v191
    s_cbranch_scc1 L_TOPL
L_SEL:
L_TOPM:
    v_mfma_f32_16x16x32_bf16 v[0:3], a[128:131], v[192:195], v[0:3]
    s_waitcnt lgkmcnt(0)
    v_fma_f32 v160, v128, s33, v242
    v_fma_f32 v161, v129, s33, v242
    v_mfma_f32_16x16x32_bf16 v[184:187], a[216:219], v[204:207], 0
    v_fma_f32 v162, v130, s33, v242
    v_exp_f32 v176, v160
    v_mfma_f32_16x16x32_bf16 v[4:7], a[132:135], v[192:195], v[4:7]
    v_fma_f32 v163, v131, s33, v242
    v_fma_f32 v164, v132, s33, v242
    v_mfma_f32_16x16x32_bf16 v[8:11], a[136:139], v[192:195], v[8:11]
    s_barrier
    v_mfma_f32_16x16x32_bf16 v[12:15], a[140:143], v[192:195], v[12:15]
    ds_read_b128 a[96:99], v208
    v_cmp_nge_f32 vcc, s39, v184
    v_mfma_f32_16x16x32_bf16 v[16:19], a[144:147], v[192:195], v[16:19]
    v_exp_f32 v177, v161
    v_fma_f32 v165, v133, s33, v242
    v_mfma_f32_16x16x32_bf16 v[20:23], a[148:151], v[192:195], v[20:23]
    s_mov_b32 m0, s30
    v_fma_f32 v166, v134, s33, v242
    v_exp_f32 v178, v162
    v_mfma_f32_16x16x32_bf16 v[24:27], a[152:155], v[192:195], v[24:27]
    s_waitcnt vmcnt(4)
    buffer_load_dwordx4 v228, s[4:7], s22 offen nt lds
    v_mfma_f32_16x16x32_bf16 v[28:31], a[156:159], v[192:195], v[28:31]
    s_cbranch_vccnz L_TRM0
L_RTM0:
    v_fma_f32 v167, v135, s33, v242
    v_add_f32 v241, v241, v184
    v_mfma_f32_16x16x32_bf16 v[32:35], a[128:131], v[196:199], v[32:35]
    ds_read_b128 a[100:103], v209
    v_exp_f32 v179, v163
    v_mfma_f32_16x16x32_bf16 v[36:39], a[132:135], v[196:199], v[36:39]
    v_exp_f32 v180, v164
    v_mfma_f32_16x16x32_bf16 v[40:43], a[136:139], v[196:199], v[40:43]
    v_cvt_pk_bf16_f32 v192, v176, v177
    v_mfma_f32_16x16x32_bf16 v[44:47], a[140:143], v[196:199], v[44:47]
    v_exp_f32 v181, v165
    v_cvt_pk_bf16_f32 v193, v178, v179
    v_mfma_f32_16x16x32_bf16 v[48:51], a[144:147], v[196:199], v[48:51]
    ds_read_b128 a[104:107], v210
    v_exp_f32 v182, v166
    v_mfma_f32_16x16x32_bf16 v[52:55], a[148:151], v[196:199], v[52:55]
    v_exp_f32 v183, v167
    v_mfma_f32_16x16x32_bf16 v[56:59], a[152:155], v[196:199], v[56:59]
    s_waitcnt vmcnt(4)
    buffer_store_dwordx4 a[208:211], v234, s[16:19], s24 offen sc0 sc1 nt
    v_mfma_f32_16x16x32_bf16 v[60:63], a[156:159], v[196:199], v[60:63]
    v_cvt_pk_bf16_f32 v194, v180, v181
    v_cvt_pk_bf16_f32 v195, v182, v183
    v_mfma_f32_16x16x32_bf16 v[128:131], a[64:67], a[0:3], 0
    v_fma_f32 v168, v136, s33, v243
    v_fma_f32 v169, v137, s33, v243
    v_mfma_f32_16x16x32_bf16 v[176:179], a[216:219], v[192:195], 0
    ds_read_b128 a[108:111], v211
    v_fma_f32 v170, v138, s33, v243
    v_mfma_f32_16x16x32_bf16 v[128:131], a[68:71], a[4:7], v[128:131]
    v_exp_f32 v184, v168
    v_fma_f32 v171, v139, s33, v243
    v_mfma_f32_16x16x32_bf16 v[128:131], a[72:75], a[8:11], v[128:131]
    v_fma_f32 v172, v140, s33, v243
    v_mfma_f32_16x16x32_bf16 v[128:131], a[76:79], a[12:15], v[128:131]
    v_exp_f32 v185, v169
    v_cmp_nge_f32 vcc, s39, v176
    v_mfma_f32_16x16x32_bf16 v[132:135], a[80:83], a[0:3], 0
    ds_read_b128 a[112:115], v208 offset:4096
    v_fma_f32 v173, v141, s33, v243
    v_mfma_f32_16x16x32_bf16 v[132:135], a[84:87], a[4:7], v[132:135]
    s_mov_b32 m0, s30
    v_fma_f32 v174, v142, s33, v243
    v_exp_f32 v186, v170
    v_mfma_f32_16x16x32_bf16 v[132:135], a[88:91], a[8:11], v[132:135]
    s_waitcnt vmcnt(4)
    buffer_load_dwordx4 v229, s[4:7], s22 offen offset:1024 nt lds
    v_mfma_f32_16x16x32_bf16 v[132:135], a[92:95], a[12:15], v[132:135]
    s_cbranch_vccnz L_TRM1
L_RTM1:
    v_fma_f32 v175, v143, s33, v243
    v_add_f32 v238, v238, v176
    v_mfma_f32_16x16x32_bf16 v[136:139], a[64:67], a[16:19], 0
    v_exp_f32 v187, v171
    v_mfma_f32_16x16x32_bf16 v[136:139], a[68:71], a[20:23], v[136:139]
    ds_read_b128 a[116:119], v209 offset:4096
    v_exp_f32 v188, v172
    v_mfma_f32_16x16x32_bf16 v[136:139], a[72:75], a[24:27], v[136:139]
    ds_read_b128 a[212:215], v236 offset:4096
    v_mfma_f32_16x16x32_bf16 v[136:139], a[76:79], a[28:31], v[136:139]
    v_cvt_pk_bf16_f32 v196, v184, v185
    v_exp_f32 v189, v173
    v_mfma_f32_16x16x32_bf16 v[140:143], a[80:83], a[16:19], 0
    v_cvt_pk_bf16_f32 v197, v186, v187
    v_mfma_f32_16x16x32_bf16 v[140:143], a[84:87], a[20:23], v[140:143]
    v_exp_f32 v190, v174
    v_mfma_f32_16x16x32_bf16 v[140:143], a[88:91], a[24:27], v[140:143]
    ds_read_b128 a[120:123], v210 offset:4096
    v_exp_f32 v191, v175
    v_mfma_f32_16x16x32_bf16 v[140:143], a[92:95], a[28:31], v[140:143]
    v_cvt_pk_bf16_f32 v198, v188, v189
    v_cvt_pk_bf16_f32 v199, v190, v191
    v_mfma_f32_16x16x32_bf16 v[64:67], a[128:131], v[200:203], v[64:67]
    v_fma_f32 v160, v144, s33, v244
    v_fma_f32 v161, v145, s33, v244
    v_fma_f32 v162, v146, s33, v244
    v_mfma_f32_16x16x32_bf16 v[184:187], a[216:219], v[196:199], 0
    v_exp_f32 v176, v160
    v_mfma_f32_16x16x32_bf16 v[68:71], a[132:135], v[200:203], v[68:71]
    ds_read_b128 a[124:127], v211 offset:4096
    v_fma_f32 v163, v147, s33, v244
    v_fma_f32 v164, v148, s33, v244
    v_mfma_f32_16x16x32_bf16 v[72:75], a[136:139], v[200:203], v[72:75]
    v_exp_f32 v177, v161
    v_mfma_f32_16x16x32_bf16 v[76:79], a[140:143], v[200:203], v[76:79]
    v_fma_f32 v165, v149, s33, v244
    v_fma_f32 v166, v150, s33, v244
    v_cmp_nge_f32 vcc, s39, v184
    v_mfma_f32_16x16x32_bf16 v[80:83], a[144:147], v[200:203], v[80:83]
    v_exp_f32 v178, v162
    v_mfma_f32_16x16x32_bf16 v[84:87], a[148:151], v[200:203], v[84:87]
    s_mov_b32 m0, s30
    v_fma_f32 v167, v151, s33, v244
    v_exp_f32 v179, v163
    v_mfma_f32_16x16x32_bf16 v[88:91], a[152:155], v[200:203], v[88:91]
    s_waitcnt vmcnt(4)
    buffer_load_dwordx4 v230, s[4:7], s22 offen offset:2048 nt lds
    v_mfma_f32_16x16x32_bf16 v[92:95], a[156:159], v[200:203], v[92:95]
    s_cbranch_vccnz L_TRM2
L_RTM2:
    v_exp_f32 v180, v164
    v_add_f32 v239, v239, v184
    v_mfma_f32_16x16x32_bf16 v[96:99], a[128:131], v[204:207], v[96:99]
    ds_read_b64_tr_b16 a[128:129], v212 offset:16384
    v_cvt_pk_bf16_f32 v200, v176, v177
    v_mfma_f32_16x16x32_bf16 v[100:103], a[132:135], v[204:207], v[100:103]
    ds_read_b64_tr_b16 a[130:131], v212 offset:20480
    v_exp_f32 v181, v165
    v_mfma_f32_16x16x32_bf16 v[104:107], a[136:139], v[204:207], v[104:107]
    ds_read_b64_tr_b16 a[132:133], v213 offset:16384
    v_cvt_pk_bf16_f32 v201, v178, v179
    v_mfma_f32_16x16x32_bf16 v[108:111], a[140:143], v[204:207], v[108:111]
    ds_read_b64_tr_b16 a[134:135], v213 offset:20480
    v_exp_f32 v182, v166
    v_mfma_f32_16x16x32_bf16 v[112:115], a[144:147], v[204:207], v[112:115]
    ds_read_b64_tr_b16 a[136:137], v214 offset:16384
    v_exp_f32 v183, v167
    v_mfma_f32_16x16x32_bf16 v[116:119], a[148:151], v[204:207], v[116:119]
    s_add_u32 m0, s25, 0
    ds_read_b64_tr_b16 a[138:139], v214 offset:20480
    v_cvt_pk_bf16_f32 v202, v180, v181
    v_mfma_f32_16x16x32_bf16 v[120:123], a[152:155], v[204:207], v[120:123]
    s_waitcnt vmcnt(4)
    buffer_load_dwordx4 v234, s[12:15], s24 offen nt lds
    v_mfma_f32_16x16x32_bf16 v[124:127], a[156:159], v[204:207], v[124:127]
    ds_read_b64_tr_b16 a[140:141], v215 offset:16384
    v_cvt_pk_bf16_f32 v203, v182, v183
    v_mfma_f32_16x16x32_bf16 v[144:147], a[64:67], a[32:35], 0
    ds_read_b64_tr_b16 a[142:143], v215 offset:20480
    v_fma_f32 v168, v152, s33, v245
    v_fma_f32 v169, v153, s33, v245
    v_mfma_f32_16x16x32_bf16 v[176:179], a[216:219], v[200:203], 0
    ds_read_b64_tr_b16 a[144:145], v216 offset:16384
    v_fma_f32 v170, v154, s33, v245
    v_mfma_f32_16x16x32_bf16 v[144:147], a[68:71], a[36:39], v[144:147]
    ds_read_b64_tr_b16 a[146:147], v216 offset:20480
    v_exp_f32 v184, v168
    v_mfma_f32_16x16x32_bf16 v[144:147], a[72:75], a[40:43], v[144:147]
    ds_read_b64_tr_b16 a[148:149], v217 offset:16384
    v_xor_b32 v234, 128, v234
    v_mfma_f32_16x16x32_bf16 v[144:147], a[76:79], a[44:47], v[144:147]
    ds_read_b64_tr_b16 a[150:151], v217 offset:20480
    v_fma_f32 v171, v155, s33, v245
    v_cmp_nge_f32 vcc, s39, v176
    v_mfma_f32_16x16x32_bf16 v[148:151], a[80:83], a[32:35], 0
    ds_read_b64_tr_b16 a[152:153], v218 offset:16384
    v_fma_f32 v172, v156, s33, v245
    v_mfma_f32_16x16x32_bf16 v[148:151], a[84:87], a[36:39], v[148:151]
    s_mov_b32 m0, s30
    ds_read_b64_tr_b16 a[154:155], v218 offset:20480
    v_exp_f32 v185, v169
    v_mfma_f32_16x16x32_bf16 v[148:151], a[88:91], a[40:43], v[148:151]
    s_waitcnt vmcnt(4)
    buffer_load_dwordx4 v231, s[4:7], s22 offen offset:3072 nt lds
    v_mfma_f32_16x16x32_bf16 v[148:151], a[92:95], a[44:47], v[148:151]
    s_cbranch_vccnz L_TRM3
L_RTM3:
    ds_read_b64_tr_b16 a[156:157], v219 offset:16384
    v_add_f32 v240, v240, v176
    v_mfma_f32_16x16x32_bf16 v[152:155], a[64:67], a[48:51], 0
    s_mov_b32 s36, s22
    ds_read_b64_tr_b16 a[158:159], v219 offset:20480
    v_fma_f32 v173, v157, s33, v245
    v_fma_f32 v174, v158, s33, v245
    v_mfma_f32_16x16x32_bf16 v[152:155], a[68:71], a[52:55], v[152:155]
    s_add_u32 s22, s22, 4096
    v_exp_f32 v186, v170
    v_fma_f32 v175, v159, s33, v245
    v_mfma_f32_16x16x32_bf16 v[152:155], a[72:75], a[56:59], v[152:155]
    s_and_b32 s35, s22, 28672
    v_exp_f32 v187, v171
    v_mfma_f32_16x16x32_bf16 v[152:155], a[76:79], a[60:63], v[152:155]
    s_cselect_b32 s35, 0, 0x1ff8000
    v_exp_f32 v188, v172
    v_cvt_pk_bf16_f32 v204, v184, v185
    v_mfma_f32_16x16x32_bf16 v[156:159], a[80:83], a[48:51], 0
    s_add_u32 s22, s22, s35
    v_exp_f32 v189, v173
    v_mfma_f32_16x16x32_bf16 v[156:159], a[84:87], a[52:55], v[156:159]
    v_cvt_pk_bf16_f32 v205, v186, v187
    v_exp_f32 v190, v174
    v_mfma_f32_16x16x32_bf16 v[156:159], a[88:91], a[56:59], v[156:159]
    s_cmp_eq_u32 s29, 65536
    v_exp_f32 v191, v175
    v_mfma_f32_16x16x32_bf16 v[156:159], a[92:95], a[60:63], v[156:159]
    s_waitcnt lgkmcnt(2)
    s_cselect_b32 s31, 0xffff0000, s38
    v_cvt_pk_bf16_f32 v206, v188, v189
    v_cvt_pk_bf16_f32 v207, v190, v191
    v_mfma_f32_16x16x32_bf16 v[0:3], a[128:131], v[192:195], v[0:3]
    v_fma_f32 v160, v128, s33, v242
    v_fma_f32 v161, v129, s33, v242
    v_mfma_f32_16x16x32_bf16 v[184:187], a[216:219], v[204:207], 0
    v_fma_f32 v162, v130, s33, v242
    v_exp_f32 v176, v160
    v_mfma_f32_16x16x32_bf16 v[4:7], a[132:135], v[192:195], v[4:7]
    v_fma_f32 v163, v131, s33, v242
    v_fma_f32 v164, v132, s33, v242
    v_mfma_f32_16x16x32_bf16 v[8:11], a[136:139], v[192:195], v[8:11]
    v_exp_f32 v177, v161
    v_mfma_f32_16x16x32_bf16 v[12:15], a[140:143], v[192:195], v[12:15]
    ds_read_b128 a[64:67], v208 offset:8192
    v_cmp_nge_f32 vcc, s39, v184
    v_mfma_f32_16x16x32_bf16 v[16:19], a[144:147], v[192:195], v[16:19]
    v_fma_f32 v165, v133, s33, v242
    v_fma_f32 v166, v134, s33, v242
    v_mfma_f32_16x16x32_bf16 v[20:23], a[148:151], v[192:195], v[20:23]
    s_add_u32 m0, s30, 16384
    v_exp_f32 v178, v162
    v_fma_f32 v167, v135, s33, v242
    v_mfma_f32_16x16x32_bf16 v[24:27], a[152:155], v[192:195], v[24:27]
    s_waitcnt vmcnt(4) lgkmcnt(1)
    buffer_load_dwordx4 v232, s[8:11], s23 offen nt lds
    v_mfma_f32_16x16x32_bf16 v[28:31], a[156:159], v[192:195], v[28:31]
    s_cbranch_vccnz L_TRM4
L_RTM4:
    v_exp_f32 v179, v163
    v_add_f32 v241, v241, v184
    v_mfma_f32_16x16x32_bf16 v[32:35], a[128:131], v[196:199], v[32:35]
    ds_read_b128 a[68:71], v209 offset:8192
    v_mfma_f32_16x16x32_bf16 v[36:39], a[132:135], v[196:199], v[36:39]
    v_exp_f32 v180, v164
    v_cvt_pk_bf16_f32 v192, v176, v177
    v_mfma_f32_16x16x32_bf16 v[40:43], a[136:139], v[196:199], v[40:43]
    v_exp_f32 v181, v165
    v_mfma_f32_16x16x32_bf16 v[44:47], a[140:143], v[196:199], v[44:47]
    v_cvt_pk_bf16_f32 v193, v178, v179
    v_exp_f32 v182, v166
    v_mfma_f32_16x16x32_bf16 v[48:51], a[144:147], v[196:199], v[48:51]
    ds_read_b128 a[72:75], v210 offset:8192
    v_mfma_f32_16x16x32_bf16 v[52:55], a[148:151], v[196:199], v[52:55]
    v_exp_f32 v183, v167
    v_cvt_pk_bf16_f32 v194, v180, v181
    v_mfma_f32_16x16x32_bf16 v[56:59], a[152:155], v[196:199], v[56:59]
    s_waitcnt vmcnt(4)
    buffer_store_dwordx4 a[212:215], v235, s[80:83], s24 offen offset:1024 sc0 sc1 nt
    v_mfma_f32_16x16x32_bf16 v[60:63], a[156:159], v[196:199], v[60:63]
    v_cvt_pk_bf16_f32 v195, v182, v183
    v_mfma_f32_16x16x32_bf16 v[128:131], a[96:99], a[0:3], 0
    v_fma_f32 v168, v136, s33, v243
    v_fma_f32 v169, v137, s33, v243
    v_mfma_f32_16x16x32_bf16 v[176:179], a[216:219], v[192:195], 0
    ds_read_b128 a[76:79], v211 offset:8192
    v_fma_f32 v170, v138, s33, v243
    v_mfma_f32_16x16x32_bf16 v[128:131], a[100:103], a[4:7], v[128:131]
    v_exp_f32 v184, v168
    v_fma_f32 v171, v139, s33, v243
    v_mfma_f32_16x16x32_bf16 v[128:131], a[104:107], a[8:11], v[128:131]
    v_fma_f32 v172, v140, s33, v243
    v_exp_f32 v185, v169
    v_mfma_f32_16x16x32_bf16 v[128:131], a[108:111], a[12:15], v[128:131]
    v_fma_f32 v173, v141, s33, v243
    v_cmp_nge_f32 vcc, s39, v176
    v_mfma_f32_16x16x32_bf16 v[132:135], a[112:115], a[0:3], 0
    ds_read_b128 a[80:83], v208 offset:12288
    v_fma_f32 v174, v142, s33, v243
    v_mfma_f32_16x16x32_bf16 v[132:135], a[116:119], a[4:7], v[132:135]
    s_add_u32 m0, s30, 16384
    v_exp_f32 v186, v170
    v_add_u32 v208, s31, v208
    v_mfma_f32_16x16x32_bf16 v[132:135], a[120:123], a[8:11], v[132:135]
    s_waitcnt vmcnt(4)
    buffer_load_dwordx4 v233, s[8:11], s23 offen offset:1024 nt lds
    v_mfma_f32_16x16x32_bf16 v[132:135], a[124:127], a[12:15], v[132:135]
    s_cbranch_vccnz L_TRM5
L_RTM5:
    v_fma_f32 v175, v143, s33, v243
    v_add_f32 v238, v238, v176
    v_mfma_f32_16x16x32_bf16 v[136:139], a[96:99], a[16:19], 0
    v_exp_f32 v187, v171
    v_exp_f32 v188, v172
    v_mfma_f32_16x16x32_bf16 v[136:139], a[100:103], a[20:23], v[136:139]
    ds_read_b128 a[84:87], v209 offset:12288
    v_cvt_pk_bf16_f32 v196, v184, v185
    v_mfma_f32_16x16x32_bf16 v[136:139], a[104:107], a[24:27], v[136:139]
    ds_read_b128 a[208:211], v236 offset:8192
    v_add_u32 v209, s31, v209
    v_mfma_f32_16x16x32_bf16 v[136:139], a[108:111], a[28:31], v[136:139]
    v_exp_f32 v189, v173
    v_mfma_f32_16x16x32_bf16 v[140:143], a[112:115], a[16:19], 0
    v_cvt_pk_bf16_f32 v197, v186, v187
    v_exp_f32 v190, v174
    v_mfma_f32_16x16x32_bf16 v[140:143], a[116:119], a[20:23], v[140:143]
    v_exp_f32 v191, v175
    v_mfma_f32_16x16x32_bf16 v[140:143], a[120:123], a[24:27], v[140:143]
    ds_read_b128 a[88:91], v210 offset:12288
    v_cvt_pk_bf16_f32 v198, v188, v189
    v_add_u32 v236, 8192, v236
    v_mfma_f32_16x16x32_bf16 v[140:143], a[124:127], a[28:31], v[140:143]
    v_cvt_pk_bf16_f32 v199, v190, v191
    v_add_u32 v210, s31, v210
    v_mfma_f32_16x16x32_bf16 v[64:67], a[128:131], v[200:203], v[64:67]
    v_fma_f32 v160, v144, s33, v244
    v_fma_f32 v161, v145, s33, v244
    v_fma_f32 v162, v146, s33, v244
    v_mfma_f32_16x16x32_bf16 v[184:187], a[216:219], v[196:199], 0
    v_exp_f32 v176, v160
    v_fma_f32 v163, v147, s33, v244
    v_mfma_f32_16x16x32_bf16 v[68:71], a[132:135], v[200:203], v[68:71]
    ds_read_b128 a[92:95], v211 offset:12288
    v_fma_f32 v164, v148, s33, v244
    v_mfma_f32_16x16x32_bf16 v[72:75], a[136:139], v[200:203], v[72:75]
    v_exp_f32 v177, v161
    v_add_u32 v211, s31, v211
    v_mfma_f32_16x16x32_bf16 v[76:79], a[140:143], v[200:203], v[76:79]
    v_fma_f32 v165, v149, s33, v244
    v_fma_f32 v166, v150, s33, v244
    v_cmp_nge_f32 vcc, s39, v184
    v_mfma_f32_16x16x32_bf16 v[80:83], a[144:147], v[200:203], v[80:83]
    v_exp_f32 v178, v162
    v_fma_f32 v167, v151, s33, v244
    v_mfma_f32_16x16x32_bf16 v[84:87], a[148:151], v[200:203], v[84:87]
    s_add_u32 m0, s30, 16384
    v_exp_f32 v179, v163
    v_mfma_f32_16x16x32_bf16 v[88:91], a[152:155], v[200:203], v[88:91]
    s_waitcnt vmcnt(4)
    buffer_load_dwordx4 v232, s[8:11], s23 offen offset:2048 nt lds
    v_mfma_f32_16x16x32_bf16 v[92:95], a[156:159], v[200:203], v[92:95]
    s_cbranch_vccnz L_TRM6
L_RTM6:
    v_exp_f32 v180, v164
    v_add_f32 v239, v239, v184
    v_mfma_f32_16x16x32_bf16 v[96:99], a[128:131], v[204:207], v[96:99]
    s_add_u32 s20, s20, 1
    ds_read_b64_tr_b16 a[128:129], v212 offset:24576
    v_cvt_pk_bf16_f32 v200, v176, v177
    v_mfma_f32_16x16x32_bf16 v[100:103], a[132:135], v[204:207], v[100:103]
    ds_read_b64_tr_b16 a[130:131], v212 offset:28672
    v_exp_f32 v181, v165
    v_cvt_pk_bf16_f32 v201, v178, v179
    v_mfma_f32_16x16x32_bf16 v[104:107], a[136:139], v[204:207], v[104:107]
    s_and_b32 s21, s20, 7
    ds_read_b64_tr_b16 a[132:133], v213 offset:24576
    v_add_u32 v212, s31, v212
    v_mfma_f32_16x16x32_bf16 v[108:111], a[140:143], v[204:207], v[108:111]
    ds_read_b64_tr_b16 a[134:135], v213 offset:28672
    v_exp_f32 v182, v166
    v_mfma_f32_16x16x32_bf16 v[112:115], a[144:147], v[204:207], v[112:115]
    ds_read_b64_tr_b16 a[136:137], v214 offset:24576
    v_add_u32 v213, s31, v213
    v_mfma_f32_16x16x32_bf16 v[116:119], a[148:151], v[204:207], v[116:119]
    s_add_u32 m0, s25, 3072
    ds_read_b64_tr_b16 a[138:139], v214 offset:28672
    v_exp_f32 v183, v167
    v_cvt_pk_bf16_f32 v202, v180, v181
    v_mfma_f32_16x16x32_bf16 v[120:123], a[152:155], v[204:207], v[120:123]
    s_waitcnt vmcnt(4)
    buffer_load_dwordx4 v235, s[12:15], s24 offen offset:1024 nt lds
    v_add_u32 v214, s31, v214
    v_mfma_f32_16x16x32_bf16 v[124:127], a[156:159], v[204:207], v[124:127]
    ds_read_b64_tr_b16 a[140:141], v215 offset:24576
    v_cvt_pk_bf16_f32 v203, v182, v183
    v_mfma_f32_16x16x32_bf16 v[144:147], a[96:99], a[32:35], 0
    s_add_u32 s28, s28, 2048
    ds_read_b64_tr_b16 a[142:143], v215 offset:28672
    v_fma_f32 v168, v152, s33, v245
    v_fma_f32 v169, v153, s33, v245
    v_mfma_f32_16x16x32_bf16 v[176:179], a[216:219], v[200:203], 0
    s_add_u32 s25, s25, 8192
    ds_read_b64_tr_b16 a[144:145], v216 offset:24576
    v_fma_f32 v170, v154, s33, v245
    v_add_u32 v215, s31, v215
    v_mfma_f32_16x16x32_bf16 v[144:147], a[100:103], a[36:39], v[144:147]
    s_xor_b32 s24, s28, s27
    ds_read_b64_tr_b16 a[146:147], v216 offset:28672
    v_exp_f32 v184, v168
    v_mfma_f32_16x16x32_bf16 v[144:147], a[104:107], a[40:43], v[144:147]
    ds_read_b64_tr_b16 a[148:149], v217 offset:24576
    v_xor_b32 v235, 128, v235
    v_add_u32 v216, s31, v216
    v_mfma_f32_16x16x32_bf16 v[144:147], a[108:111], a[44:47], v[144:147]
    ds_read_b64_tr_b16 a[150:151], v217 offset:28672
    v_cmp_nge_f32 vcc, s39, v176
    v_mfma_f32_16x16x32_bf16 v[148:151], a[112:115], a[32:35], 0
    ds_read_b64_tr_b16 a[152:153], v218 offset:24576
    v_fma_f32 v171, v155, s33, v245
    v_add_u32 v217, s31, v217
    v_mfma_f32_16x16x32_bf16 v[148:151], a[116:119], a[36:39], v[148:151]
    s_add_u32 m0, s30, 16384
    ds_read_b64_tr_b16 a[154:155], v218 offset:28672
    v_fma_f32 v172, v156, s33, v245
    v_mfma_f32_16x16x32_bf16 v[148:151], a[120:123], a[40:43], v[148:151]
    s_waitcnt vmcnt(4)
    buffer_load_dwordx4 v233, s[8:11], s23 offen offset:3072 nt lds
    v_add_u32 v218, s31, v218
    v_mfma_f32_16x16x32_bf16 v[148:151], a[124:127], a[44:47], v[148:151]
    s_add_u32 s30, s29, s32
    ds_read_b64_tr_b16 a[156:157], v219 offset:24576
    v_exp_f32 v185, v169
    v_mfma_f32_16x16x32_bf16 v[152:155], a[96:99], a[48:51], 0
    s_mov_b32 s23, s36
    ds_read_b64_tr_b16 a[158:159], v219 offset:28672
    v_fma_f32 v173, v157, s33, v245
    v_fma_f32 v174, v158, s33, v245
    v_mfma_f32_16x16x32_bf16 v[152:155], a[100:103], a[52:55], v[152:155]
    s_add_u32 s29, s29, s31
    v_exp_f32 v186, v170
    v_add_u32 v219, s31, v219
    v_mfma_f32_16x16x32_bf16 v[152:155], a[104:107], a[56:59], v[152:155]
    s_cbranch_vccnz L_TRM7
L_RTM7:
    v_fma_f32 v175, v159, s33, v245
    v_add_f32 v240, v240, v176
    v_mfma_f32_16x16x32_bf16 v[152:155], a[108:111], a[60:63], v[152:155]
    v_exp_f32 v187, v171
    v_exp_f32 v188, v172
    v_mfma_f32_16x16x32_bf16 v[156:159], a[112:115], a[48:51], 0
    v_cvt_pk_bf16_f32 v204, v184, v185
    v_exp_f32 v189, v173
    v_mfma_f32_16x16x32_bf16 v[156:159], a[116:119], a[52:55], v[156:159]
    v_cvt_pk_bf16_f32 v205, v186, v187
    v_mfma_f32_16x16x32_bf16 v[156:159], a[120:123], a[56:59], v[156:159]
    s_waitcnt vmcnt(10)
    v_exp_f32 v190, v174
    v_exp_f32 v191, v175
    v_mfma_f32_16x16x32_bf16 v[156:159], a[124:127], a[60:63], v[156:159]
    s_waitcnt lgkmcnt(2)
    s_cmp_lg_u32 s21, 7
    v_cvt_pk_bf16_f32 v206, v188, v189
    v_cvt_pk_bf16_f32 v207, v190, v191
    s_cbranch_scc1 L_TOPM
L_TOPZ:
    v_mfma_f32_16x16x32_bf16 v[0:3], a[128:131], v[192:195], v[0:3]
    s_waitcnt lgkmcnt(0)
    v_fma_f32 v160, v128, s33, v242
    v_fma_f32 v161, v129, s33, v242
    v_mfma_f32_16x16x32_bf16 v[184:187], a[216:219], v[204:207], 0
    v_fma_f32 v162, v130, s33, v242
    v_exp_f32 v176, v160
    v_mfma_f32_16x16x32_bf16 v[4:7], a[132:135], v[192:195], v[4:7]
    v_fma_f32 v163, v131, s33, v242
    v_fma_f32 v164, v132, s33, v242
    v_mfma_f32_16x16x32_bf16 v[8:11], a[136:139], v[192:195], v[8:11]
    s_barrier
    v_mfma_f32_16x16x32_bf16 v[12:15], a[140:143], v[192:195], v[12:15]
    ds_read_b128 a[96:99], v208
    v_cmp_nge_f32 vcc, s39, v184
    v_mfma_f32_16x16x32_bf16 v[16:19], a[144:147], v[192:195], v[16:19]
    v_exp_f32 v177, v161
    v_fma_f32 v165, v133, s33, v242
    v_mfma_f32_16x16x32_bf16 v[20:23], a[148:151], v[192:195], v[20:23]
    s_mov_b32 m0, s30
    v_fma_f32 v166, v134, s33, v242
    v_exp_f32 v178, v162
    v_mfma_f32_16x16x32_bf16 v[24:27], a[152:155], v[192:195], v[24:27]
    s_waitcnt vmcnt(4)
    buffer_load_dwordx4 v228, s[4:7], s22 offen nt lds
    v_mfma_f32_16x16x32_bf16 v[28:31], a[156:159], v[192:195], v[28:31]
    s_cbranch_vccnz L_TRZ0
L_RTZ0:
    v_fma_f32 v167, v135, s33, v242
    v_add_f32 v241, v241, v184
    v_mfma_f32_16x16x32_bf16 v[32:35], a[128:131], v[196:199], v[32:35]
    ds_read_b128 a[100:103], v209
    v_exp_f32 v179, v163
    v_mfma_f32_16x16x32_bf16 v[36:39], a[132:135], v[196:199], v[36:39]
    v_exp_f32 v180, v164
    v_mfma_f32_16x16x32_bf16 v[40:43], a[136:139], v[196:199], v[40:43]
    v_cvt_pk_bf16_f32 v192, v176, v177
    v_mfma_f32_16x16x32_bf16 v[44:47], a[140:143], v[196:199], v[44:47]
    v_exp_f32 v181, v165
    v_cvt_pk_bf16_f32 v193, v178, v179
    v_mfma_f32_16x16x32_bf16 v[48:51], a[144:147], v[196:199], v[48:51]
    ds_read_b128 a[104:107], v210
    v_exp_f32 v182, v166
    v_mfma_f32_16x16x32_bf16 v[52:55], a[148:151], v[196:199], v[52:55]
    v_exp_f32 v183, v167
    v_mfma_f32_16x16x32_bf16 v[56:59], a[152:155], v[196:199], v[56:59]
    s_waitcnt vmcnt(4)
    buffer_store_dwordx4 a[192:195], v228, s[16:19], s27 offen sc0 sc1 nt
    v_mfma_f32_16x16x32_bf16 v[60:63], a[156:159], v[196:199], v[60:63]
    v_cvt_pk_bf16_f32 v194, v180, v181
    v_cvt_pk_bf16_f32 v195, v182, v183
    v_mfma_f32_16x16x32_bf16 v[128:131], a[64:67], a[0:3], 0
    v_fma_f32 v168, v136, s33, v243
    v_fma_f32 v169, v137, s33, v243
    v_mfma_f32_16x16x32_bf16 v[176:179], a[216:219], v[192:195], 0
    ds_read_b128 a[108:111], v211
    v_fma_f32 v170, v138, s33, v243
    v_mfma_f32_16x16x32_bf16 v[128:131], a[68:71], a[4:7], v[128:131]
    v_exp_f32 v184, v168
    v_mfma_f32_16x16x32_bf16 v[128:131], a[72:75], a[8:11], v[128:131]
    v_fma_f32 v171, v139, s33, v243
    v_fma_f32 v172, v140, s33, v243
    v_mfma_f32_16x16x32_bf16 v[128:131], a[76:79], a[12:15], v[128:131]
    v_exp_f32 v185, v169
    v_cmp_nge_f32 vcc, s39, v176
    v_mfma_f32_16x16x32_bf16 v[132:135], a[80:83], a[0:3], 0
    ds_read_b128 a[112:115], v208 offset:4096
    v_fma_f32 v173, v141, s33, v243
    v_mfma_f32_16x16x32_bf16 v[132:135], a[84:87], a[4:7], v[132:135]
    s_mov_b32 m0, s30
    v_fma_f32 v174, v142, s33, v243
    v_exp_f32 v186, v170
    v_mfma_f32_16x16x32_bf16 v[132:135], a[88:91], a[8:11], v[132:135]
    s_waitcnt vmcnt(4)
    buffer_load_dwordx4 v229, s[4:7], s22 offen offset:1024 nt lds
    v_mfma_f32_16x16x32_bf16 v[132:135], a[92:95], a[12:15], v[132:135]
    s_cbranch_vccnz L_TRZ1
L_RTZ1:
    v_add_f32 v238, v238, v176
    v_mfma_f32_16x16x32_bf16 v[136:139], a[64:67], a[16:19], 0
    v_fma_f32 v175, v143, s33, v243
    v_exp_f32 v187, v171
    v_mfma_f32_16x16x32_bf16 v[136:139], a[68:71], a[20:23], v[136:139]
    ds_read_b128 a[116:119], v209 offset:4096
    v_mfma_f32_16x16x32_bf16 v[136:139], a[72:75], a[24:27], v[136:139]
    v_exp_f32 v188, v172
    v_cvt_pk_bf16_f32 v196, v184, v185
    v_mfma_f32_16x16x32_bf16 v[136:139], a[76:79], a[28:31], v[136:139]
    v_exp_f32 v189, v173
    v_mfma_f32_16x16x32_bf16 v[140:143], a[80:83], a[16:19], 0
    v_cvt_pk_bf16_f32 v197, v186, v187
    v_mfma_f32_16x16x32_bf16 v[140:143], a[84:87], a[20:23], v[140:143]
    ds_read_b128 a[120:123], v210 offset:4096
    v_exp_f32 v190, v174
    v_mfma_f32_16x16x32_bf16 v[140:143], a[88:91], a[24:27], v[140:143]
    v_exp_f32 v191, v175
    v_mfma_f32_16x16x32_bf16 v[140:143], a[92:95], a[28:31], v[140:143]
    v_cvt_pk_bf16_f32 v198, v188, v189
    v_cvt_pk_bf16_f32 v199, v190, v191
    v_mfma_f32_16x16x32_bf16 v[64:67], a[128:131], v[200:203], v[64:67]
    v_fma_f32 v160, v144, s33, v244
    v_fma_f32 v161, v145, s33, v244
    v_fma_f32 v162, v146, s33, v244
    v_mfma_f32_16x16x32_bf16 v[184:187], a[216:219], v[196:199], 0
    ds_read_b128 a[0:3], v246
    v_exp_f32 v176, v160
    v_mfma_f32_16x16x32_bf16 v[68:71], a[132:135], v[200:203], v[68:71]
    ds_read_b128 a[124:127], v211 offset:4096
    v_fma_f32 v163, v147, s33, v244
    v_fma_f32 v164, v148, s33, v244
    v_mfma_f32_16x16x32_bf16 v[72:75], a[136:139], v[200:203], v[72:75]
    v_exp_f32 v177, v161
    v_mfma_f32_16x16x32_bf16 v[76:79], a[140:143], v[200:203], v[76:79]
    v_fma_f32 v165, v149, s33, v244
    v_fma_f32 v166, v150, s33, v244
    v_cmp_nge_f32 vcc, s39, v184
    v_mfma_f32_16x16x32_bf16 v[80:83], a[144:147], v[200:203], v[80:83]
    v_exp_f32 v178, v162
    v_fma_f32 v167, v151, s33, v244
    v_mfma_f32_16x16x32_bf16 v[84:87], a[148:151], v[200:203], v[84:87]
    s_mov_b32 m0, s30
    ds_read_b128 a[4:7], v247
    v_exp_f32 v179, v163
    v_mfma_f32_16x16x32_bf16 v[88:91], a[152:155], v[200:203], v[88:91]
    s_waitcnt vmcnt(4)
    buffer_load_dwordx4 v230, s[4:7], s22 offen offset:2048 nt lds
    v_mfma_f32_16x16x32_bf16 v[92:95], a[156:159], v[200:203], v[92:95]
    s_cbranch_vccnz L_TRZ2
L_RTZ2:
    v_exp_f32 v180, v164
    v_add_f32 v239, v239, v184
    v_mfma_f32_16x16x32_bf16 v[96:99], a[128:131], v[204:207], v[96:99]
    ds_read_b64_tr_b16 a[128:129], v212 offset:16384
    v_cvt_pk_bf16_f32 v200, v176, v177
    v_mfma_f32_16x16x32_bf16 v[100:103], a[132:135], v[204:207], v[100:103]
    ds_read_b64_tr_b16 a[130:131], v212 offset:20480
    ds_read_b128 a[8:11], v248
    v_exp_f32 v181, v165
    v_mfma_f32_16x16x32_bf16 v[104:107], a[136:139], v[204:207], v[104:107]
    ds_read_b64_tr_b16 a[132:133], v213 offset:16384
    v_cvt_pk_bf16_f32 v201, v178, v179
    v_mfma_f32_16x16x32_bf16 v[108:111], a[140:143], v[204:207], v[108:111]
    ds_read_b64_tr_b16 a[134:135], v213 offset:20480
    v_exp_f32 v182, v166
    v_mfma_f32_16x16x32_bf16 v[112:115], a[144:147], v[204:207], v[112:115]
    ds_read_b64_tr_b16 a[136:137], v214 offset:16384
    v_exp_f32 v183, v167
    v_mfma_f32_16x16x32_bf16 v[116:119], a[148:151], v[204:207], v[116:119]
    ds_read_b64_tr_b16 a[138:139], v214 offset:20480
    ds_read_b128 a[12:15], v249
    v_cvt_pk_bf16_f32 v202, v180, v181
    v_mfma_f32_16x16x32_bf16 v[120:123], a[152:155], v[204:207], v[120:123]
    s_waitcnt vmcnt(4)
    buffer_store_dwordx4 a[196:199], v229, s[16:19], s27 offen offset:1024 sc0 sc1 nt
    v_mfma_f32_16x16x32_bf16 v[124:127], a[156:159], v[204:207], v[124:127]
    ds_read_b64_tr_b16 a[140:141], v215 offset:16384
    v_cvt_pk_bf16_f32 v203, v182, v183
    v_mfma_f32_16x16x32_bf16 v[144:147], a[64:67], a[32:35], 0
    ds_read_b64_tr_b16 a[142:143], v215 offset:20480
    v_fma_f32 v168, v152, s33, v245
    v_fma_f32 v169, v153, s33, v245
    v_mfma_f32_16x16x32_bf16 v[176:179], a[216:219], v[200:203], 0
    ds_read_b64_tr_b16 a[144:145], v216 offset:16384
    ds_read_b128 a[16:19], v246 offset:16384
    v_mfma_f32_16x16x32_bf16 v[144:147], a[68:71], a[36:39], v[144:147]
    ds_read_b64_tr_b16 a[146:147], v216 offset:20480
    v_fma_f32 v170, v154, s33, v245
    v_exp_f32 v184, v168
    v_mfma_f32_16x16x32_bf16 v[144:147], a[72:75], a[40:43], v[144:147]
    ds_read_b64_tr_b16 a[148:149], v217 offset:16384
    v_fma_f32 v171, v155, s33, v245
    v_mfma_f32_16x16x32_bf16 v[144:147], a[76:79], a[44:47], v[144:147]
    ds_read_b64_tr_b16 a[150:151], v217 offset:20480
    v_fma_f32 v172, v156, s33, v245
    v_cmp_nge_f32 vcc, s39, v176
    v_mfma_f32_16x16x32_bf16 v[148:151], a[80:83], a[32:35], 0
    ds_read_b64_tr_b16 a[152:153], v218 offset:16384
    v_exp_f32 v185, v169
    v_mfma_f32_16x16x32_bf16 v[148:151], a[84:87], a[36:39], v[148:151]
    s_mov_b32 m0, s30
    ds_read_b128 a[20:23], v247 offset:16384
    v_fma_f32 v173, v157, s33, v245
    v_mfma_f32_16x16x32_bf16 v[148:151], a[88:91], a[40:43], v[148:151]
    s_waitcnt vmcnt(4)
    buffer_load_dwordx4 v231, s[4:7], s22 offen offset:3072 nt lds
    v_mfma_f32_16x16x32_bf16 v[148:151], a[92:95], a[44:47], v[148:151]
    s_cbranch_vccnz L_TRZ3
L_RTZ3:
    ds_read_b64_tr_b16 a[154:155], v218 offset:20480
    v_fma_f32 v174, v158, s33, v245
    v_add_f32 v240, v240, v176
    v_mfma_f32_16x16x32_bf16 v[152:155], a[64:67], a[48:51], 0
    s_mov_b32 s36, s22
    ds_read_b64_tr_b16 a[156:157], v219 offset:16384
    v_exp_f32 v186, v170
    v_mfma_f32_16x16x32_bf16 v[152:155], a[68:71], a[52:55], v[152:155]
    s_add_u32 s22, s22, 4096
    ds_read_b128 a[24:27], v248 offset:16384
    v_fma_f32 v175, v159, s33, v245
    v_mfma_f32_16x16x32_bf16 v[152:155], a[72:75], a[56:59], v[152:155]
    s_and_b32 s35, s22, 28672
    ds_read_b64_tr_b16 a[158:159], v219 offset:20480
    v_exp_f32 v187, v171
    v_mfma_f32_16x16x32_bf16 v[152:155], a[76:79], a[60:63], v[152:155]
    s_cselect_b32 s35, 0, 0x1ff8000
    v_exp_f32 v188, v172
    v_mfma_f32_16x16x32_bf16 v[156:159], a[80:83], a[48:51], 0
    s_add_u32 s22, s22, s35
    v_cvt_pk_bf16_f32 v204, v184, v185
    v_exp_f32 v189, v173
    v_mfma_f32_16x16x32_bf16 v[156:159], a[84:87], a[52:55], v[156:159]
    ds_read_b128 a[28:31], v249 offset:16384
    v_cvt_pk_bf16_f32 v205, v186, v187
    v_mfma_f32_16x16x32_bf16 v[156:159], a[88:91], a[56:59], v[156:159]
    s_cmp_eq_u32 s29, 65536
    v_exp_f32 v190, v174
    v_exp_f32 v191, v175
    v_mfma_f32_16x16x32_bf16 v[156:159], a[92:95], a[60:63], v[156:159]
    s_waitcnt lgkmcnt(5)
    s_cselect_b32 s31, 0xffff0000, s38
    v_cvt_pk_bf16_f32 v206, v188, v189
    v_cvt_pk_bf16_f32 v207, v190, v191
    v_mfma_f32_16x16x32_bf16 v[0:3], a[128:131], v[192:195], v[0:3]
    v_fma_f32 v160, v128, s33, v242
    v_fma_f32 v161, v129, s33, v242
    v_mfma_f32_16x16x32_bf16 v[184:187], a[216:219], v[204:207], 0
    v_fma_f32 v162, v130, s33, v242
    v_exp_f32 v176, v160
    v_mfma_f32_16x16x32_bf16 v[4:7], a[132:135], v[192:195], v[4:7]
    v_fma_f32 v163, v131, s33, v242
    v_fma_f32 v164, v132, s33, v242
    v_mfma_f32_16x16x32_bf16 v[8:11], a[136:139], v[192:195], v[8:11]
    v_exp_f32 v177, v161
    v_mfma_f32_16x16x32_bf16 v[12:15], a[140:143], v[192:195], v[12:15]
    ds_read_b128 a[64:67], v208 offset:8192
    v_fma_f32 v165, v133, s33, v242
    v_cmp_nge_f32 vcc, s39, v184
    v_mfma_f32_16x16x32_bf16 v[16:19], a[144:147], v[192:195], v[16:19]
    v_fma_f32 v166, v134, s33, v242
    v_mfma_f32_16x16x32_bf16 v[20:23], a[148:151], v[192:195], v[20:23]
    s_waitcnt lgkmcnt(2)
    s_add_u32 m0, s30, 16384
    v_exp_f32 v178, v162
    v_fma_f32 v167, v135, s33, v242
    v_mfma_f32_16x16x32_bf16 v[24:27], a[152:155], v[192:195], v[24:27]
    s_waitcnt vmcnt(4)
    buffer_load_dwordx4 v232, s[8:11], s23 offen nt lds
    v_mfma_f32_16x16x32_bf16 v[28:31], a[156:159], v[192:195], v[28:31]
    s_cbranch_vccnz L_TRZ4
L_RTZ4:
    ds_read_b128 a[68:71], v209 offset:8192
    v_add_f32 v241, v241, v184
    v_mfma_f32_16x16x32_bf16 v[32:35], a[128:131], v[196:199], v[32:35]
    v_exp_f32 v179, v163
    v_mfma_f32_16x16x32_bf16 v[36:39], a[132:135], v[196:199], v[36:39]
    v_exp_f32 v180, v164
    v_cvt_pk_bf16_f32 v192, v176, v177
    v_mfma_f32_16x16x32_bf16 v[40:43], a[136:139], v[196:199], v[40:43]
    ds_read_b128 a[72:75], v210 offset:8192
    v_exp_f32 v181, v165
    v_mfma_f32_16x16x32_bf16 v[44:47], a[140:143], v[196:199], v[44:47]
    v_cvt_pk_bf16_f32 v193, v178, v179
    v_mfma_f32_16x16x32_bf16 v[48:51], a[144:147], v[196:199], v[48:51]
    v_exp_f32 v182, v166
    v_mfma_f32_16x16x32_bf16 v[52:55], a[148:151], v[196:199], v[52:55]
    ds_read_b128 a[76:79], v211 offset:8192
    v_exp_f32 v183, v167
    v_mfma_f32_16x16x32_bf16 v[56:59], a[152:155], v[196:199], v[56:59]
    s_waitcnt vmcnt(4)
    buffer_store_dwordx4 a[200:203], v230, s[16:19], s27 offen offset:2048 sc0 sc1 nt
    v_mfma_f32_16x16x32_bf16 v[60:63], a[156:159], v[196:199], v[60:63]
    v_cvt_pk_bf16_f32 v194, v180, v181
    v_cvt_pk_bf16_f32 v195, v182, v183
    v_mfma_f32_16x16x32_bf16 v[128:131], a[96:99], a[0:3], 0
    v_fma_f32 v168, v136, s33, v243
    v_fma_f32 v169, v137, s33, v243
    v_fma_f32 v170, v138, s33, v243
    v_mfma_f32_16x16x32_bf16 v[176:179], a[216:219], v[192:195], 0
    v_exp_f32 v184, v168
    v_mfma_f32_16x16x32_bf16 v[128:131], a[100:103], a[4:7], v[128:131]
    ds_read_b128 a[80:83], v208 offset:12288
    v_fma_f32 v171, v139, s33, v243
    v_fma_f32 v172, v140, s33, v243
    v_mfma_f32_16x16x32_bf16 v[128:131], a[104:107], a[8:11], v[128:131]
    s_waitcnt vmcnt(5)
    ds_read_b128 a[32:35], v246 offset:32768
    v_add_u32 v208, s31, v208
    v_mfma_f32_16x16x32_bf16 v[128:131], a[108:111], a[12:15], v[128:131]
    v_exp_f32 v185, v169
    v_fma_f32 v173, v141, s33, v243
    v_cmp_nge_f32 vcc, s39, v176
    v_mfma_f32_16x16x32_bf16 v[132:135], a[112:115], a[0:3], 0
    ds_read_b128 a[36:39], v247 offset:32768
    v_fma_f32 v174, v142, s33, v243
    v_mfma_f32_16x16x32_bf16 v[132:135], a[116:119], a[4:7], v[132:135]
    s_add_u32 m0, s30, 16384
    v_exp_f32 v186, v170
    v_fma_f32 v175, v143, s33, v243
    v_mfma_f32_16x16x32_bf16 v[132:135], a[120:123], a[8:11], v[132:135]
    s_waitcnt vmcnt(4)
    buffer_load_dwordx4 v233, s[8:11], s23 offen offset:1024 nt lds
    v_mfma_f32_16x16x32_bf16 v[132:135], a[124:127], a[12:15], v[132:135]
    s_cbranch_vccnz L_TRZ5
L_RTZ5:
    ds_read_b128 a[40:43], v248 offset:32768
    v_add_f32 v238, v238, v176
    v_mfma_f32_16x16x32_bf16 v[136:139], a[96:99], a[16:19], 0
    ds_read_b128 a[84:87], v209 offset:12288
    v_exp_f32 v187, v171
    v_mfma_f32_16x16x32_bf16 v[136:139], a[100:103], a[20:23], v[136:139]
    ds_read_b128 a[44:47], v249 offset:32768
    v_exp_f32 v188, v172
    v_add_u32 v209, s31, v209
    v_mfma_f32_16x16x32_bf16 v[136:139], a[104:107], a[24:27], v[136:139]
    s_waitcnt lgkmcnt(6)
    v_cvt_pk_bf16_f32 v196, v184, v185
    v_mfma_f32_16x16x32_bf16 v[136:139], a[108:111], a[28:31], v[136:139]
    ds_read_b128 a[48:51], v246 offset:49152
    v_exp_f32 v189, v173
    v_mfma_f32_16x16x32_bf16 v[140:143], a[112:115], a[16:19], 0
    v_cvt_pk_bf16_f32 v197, v186, v187
    v_exp_f32 v190, v174
    v_mfma_f32_16x16x32_bf16 v[140:143], a[116:119], a[20:23], v[140:143]
    ds_read_b128 a[52:55], v247 offset:49152
    v_exp_f32 v191, v175
    v_mfma_f32_16x16x32_bf16 v[140:143], a[120:123], a[24:27], v[140:143]
    ds_read_b128 a[88:91], v210 offset:12288
    v_cvt_pk_bf16_f32 v198, v188, v189
    v_cvt_pk_bf16_f32 v199, v190, v191
    v_mfma_f32_16x16x32_bf16 v[140:143], a[124:127], a[28:31], v[140:143]
    ds_read_b128 a[56:59], v248 offset:49152
    v_add_u32 v210, s31, v210
    v_mfma_f32_16x16x32_bf16 v[64:67], a[128:131], v[200:203], v[64:67]
    v_fma_f32 v160, v144, s33, v244
    v_fma_f32 v161, v145, s33, v244
    v_fma_f32 v162, v146, s33, v244
    v_mfma_f32_16x16x32_bf16 v[184:187], a[216:219], v[196:199], 0
    ds_read_b128 a[60:63], v249 offset:49152
    v_exp_f32 v176, v160
    v_mfma_f32_16x16x32_bf16 v[68:71], a[132:135], v[200:203], v[68:71]
    v_fma_f32 v163, v147, s33, v244
    v_fma_f32 v164, v148, s33, v244
    v_mfma_f32_16x16x32_bf16 v[72:75], a[136:139], v[200:203], v[72:75]
    ds_read_b128 a[92:95], v211 offset:12288
    v_exp_f32 v177, v161
    v_mfma_f32_16x16x32_bf16 v[76:79], a[140:143], v[200:203], v[76:79]
    v_fma_f32 v165, v149, s33, v244
    v_cmp_nge_f32 vcc, s39, v184
    v_add_u32 v211, s31, v211
    v_mfma_f32_16x16x32_bf16 v[80:83], a[144:147], v[200:203], v[80:83]
    v_fma_f32 v166, v150, s33, v244
    v_exp_f32 v178, v162
    v_mfma_f32_16x16x32_bf16 v[84:87], a[148:151], v[200:203], v[84:87]
    s_add_u32 m0, s30, 16384
    v_fma_f32 v167, v151, s33, v244
    v_exp_f32 v179, v163
    v_mfma_f32_16x16x32_bf16 v[88:91], a[152:155], v[200:203], v[88:91]
    s_waitcnt vmcnt(4)
    buffer_load_dwordx4 v232, s[8:11], s23 offen offset:2048 nt lds
    v_mfma_f32_16x16x32_bf16 v[92:95], a[156:159], v[200:203], v[92:95]
    s_cbranch_vccnz L_TRZ6
L_RTZ6:
    v_exp_f32 v180, v164
    v_add_f32 v239, v239, v184
    v_mfma_f32_16x16x32_bf16 v[96:99], a[128:131], v[204:207], v[96:99]
    s_add_u32 s20, s20, 1
    ds_read_b64_tr_b16 a[128:129], v212 offset:24576
    v_cvt_pk_bf16_f32 v200, v176, v177
    v_mfma_f32_16x16x32_bf16 v[100:103], a[132:135], v[204:207], v[100:103]
    ds_read_b64_tr_b16 a[130:131], v212 offset:28672
    v_exp_f32 v181, v165
    v_cvt_pk_bf16_f32 v201, v178, v179
    v_mfma_f32_16x16x32_bf16 v[104:107], a[136:139], v[204:207], v[104:107]
    ds_read_b64_tr_b16 a[132:133], v213 offset:24576
    v_add_u32 v212, s31, v212
    v_mfma_f32_16x16x32_bf16 v[108:111], a[140:143], v[204:207], v[108:111]
    ds_read_b64_tr_b16 a[134:135], v213 offset:28672
    v_exp_f32 v182, v166
    v_mfma_f32_16x16x32_bf16 v[112:115], a[144:147], v[204:207], v[112:115]
    ds_read_b64_tr_b16 a[136:137], v214 offset:24576
    v_exp_f32 v183, v167
    v_add_u32 v213, s31, v213
    v_mfma_f32_16x16x32_bf16 v[116:119], a[148:151], v[204:207], v[116:119]
    ds_read_b64_tr_b16 a[138:139], v214 offset:28672
    v_cvt_pk_bf16_f32 v202, v180, v181
    v_mfma_f32_16x16x32_bf16 v[120:123], a[152:155], v[204:207], v[120:123]
    s_waitcnt vmcnt(4)
    buffer_store_dwordx4 a[204:207], v231, s[16:19], s27 offen offset:3072 sc0 sc1 nt
    v_add_u32 v214, s31, v214
    v_mfma_f32_16x16x32_bf16 v[124:127], a[156:159], v[204:207], v[124:127]
    s_waitcnt lgkmcnt(6)
    ds_read_b64_tr_b16 a[140:141], v215 offset:24576
    v_cvt_pk_bf16_f32 v203, v182, v183
    v_mfma_f32_16x16x32_bf16 v[144:147], a[96:99], a[32:35], 0
    ds_read_b64_tr_b16 a[142:143], v215 offset:28672
    v_fma_f32 v168, v152, s33, v245
    v_fma_f32 v169, v153, s33, v245
    v_mfma_f32_16x16x32_bf16 v[176:179], a[216:219], v[200:203], 0
    ds_read_b64_tr_b16 a[144:145], v216 offset:24576
    v_add_u32 v215, s31, v215
    v_mfma_f32_16x16x32_bf16 v[144:147], a[100:103], a[36:39], v[144:147]
    ds_read_b64_tr_b16 a[146:147], v216 offset:28672
    v_fma_f32 v170, v154, s33, v245
    v_exp_f32 v184, v168
    v_mfma_f32_16x16x32_bf16 v[144:147], a[104:107], a[40:43], v[144:147]
    ds_read_b64_tr_b16 a[148:149], v217 offset:24576
    v_add_u32 v216, s31, v216
    v_mfma_f32_16x16x32_bf16 v[144:147], a[108:111], a[44:47], v[144:147]
    ds_read_b64_tr_b16 a[150:151], v217 offset:28672
    v_fma_f32 v171, v155, s33, v245
    v_cmp_nge_f32 vcc, s39, v176
    v_mfma_f32_16x16x32_bf16 v[148:151], a[112:115], a[32:35], 0
    ds_read_b64_tr_b16 a[152:153], v218 offset:24576
    v_add_u32 v217, s31, v217
    v_mfma_f32_16x16x32_bf16 v[148:151], a[116:119], a[36:39], v[148:151]
    s_add_u32 m0, s30, 16384
    ds_read_b64_tr_b16 a[154:155], v218 offset:28672
    v_fma_f32 v172, v156, s33, v245
    v_mfma_f32_16x16x32_bf16 v[148:151], a[120:123], a[40:43], v[148:151]
    s_waitcnt vmcnt(4)
    buffer_load_dwordx4 v233, s[8:11], s23 offen offset:3072 nt lds
    v_add_u32 v218, s31, v218
    v_mfma_f32_16x16x32_bf16 v[148:151], a[124:127], a[44:47], v[148:151]
    s_add_u32 s30, s29, s32
    ds_read_b64_tr_b16 a[156:157], v219 offset:24576
    v_exp_f32 v185, v169
    v_fma_f32 v173, v157, s33, v245
    v_mfma_f32_16x16x32_bf16 v[152:155], a[96:99], a[48:51], 0
    s_mov_b32 s23, s36
    ds_read_b64_tr_b16 a[158:159], v219 offset:28672
    v_fma_f32 v174, v158, s33, v245
    v_mfma_f32_16x16x32_bf16 v[152:155], a[100:103], a[52:55], v[152:155]
    s_add_u32 s29, s29, s31
    v_exp_f32 v186, v170
    v_add_u32 v219, s31, v219
    v_mfma_f32_16x16x32_bf16 v[152:155], a[104:107], a[56:59], v[152:155]
    s_cbranch_vccnz L_TRZ7
L_RTZ7:
    v_fma_f32 v175, v159, s33, v245
    v_add_f32 v240, v240, v176
    v_mfma_f32_16x16x32_bf16 v[152:155], a[108:111], a[60:63], v[152:155]
    v_exp_f32 v187, v171
    v_exp_f32 v188, v172
    v_mfma_f32_16x16x32_bf16 v[156:159], a[112:115], a[48:51], 0
    v_cvt_pk_bf16_f32 v204, v184, v185
    v_exp_f32 v189, v173
    v_mfma_f32_16x16x32_bf16 v[156:159], a[116:119], a[52:55], v[156:159]
    v_cvt_pk_bf16_f32 v205, v186, v187
    v_mfma_f32_16x16x32_bf16 v[156:159], a[120:123], a[56:59], v[156:159]
    s_waitcnt vmcnt(8)
    v_exp_f32 v190, v174
    v_exp_f32 v191, v175
    v_mfma_f32_16x16x32_bf16 v[156:159], a[124:127], a[60:63], v[156:159]
    s_waitcnt lgkmcnt(2)
    v_cvt_pk_bf16_f32 v206, v188, v189
    v_cvt_pk_bf16_f32 v207, v190, v191
    s_branch L_TOPE
L_TOPL:
    v_mfma_f32_16x16x32_bf16 v[0:3], a[128:131], v[192:195], v[0:3]
    s_waitcnt lgkmcnt(0)
    v_fma_f32 v160, v128, s33, v242
    v_fma_f32 v161, v129, s33, v242
    v_mfma_f32_16x16x32_bf16 v[184:187], a[216:219], v[204:207], 0
    v_fma_f32 v162, v130, s33, v242
    v_exp_f32 v176, v160
    v_mfma_f32_16x16x32_bf16 v[4:7], a[132:135], v[192:195], v[4:7]
    v_fma_f32 v163, v131, s33, v242
    v_fma_f32 v164, v132, s33, v242
    v_mfma_f32_16x16x32_bf16 v[8:11], a[136:139], v[192:195], v[8:11]
    s_barrier
    v_mfma_f32_16x16x32_bf16 v[12:15], a[140:143], v[192:195], v[12:15]
    ds_read_b128 a[96:99], v208
    v_cmp_nge_f32 vcc, s39, v184
    v_mfma_f32_16x16x32_bf16 v[16:19], a[144:147], v[192:195], v[16:19]
    v_exp_f32 v177, v161
    v_fma_f32 v165, v133, s33, v242
    v_mfma_f32_16x16x32_bf16 v[20:23], a[148:151], v[192:195], v[20:23]
    s_mov_b32 m0, s30
    v_fma_f32 v166, v134, s33, v242
    v_exp_f32 v178, v162
    v_mfma_f32_16x16x32_bf16 v[24:27], a[152:155], v[192:195], v[24:27]
    buffer_load_dwordx4 v228, s[4:7], s22 offen nt lds
    v_mfma_f32_16x16x32_bf16 v[28:31], a[156:159], v[192:195], v[28:31]
    s_cbranch_vccnz L_TRL0
L_RTL0:
    v_fma_f32 v167, v135, s33, v242
    v_add_f32 v241, v241, v184
    v_mfma_f32_16x16x32_bf16 v[32:35], a[128:131], v[196:199], v[32:35]
    ds_read_b128 a[100:103], v209
    v_exp_f32 v179, v163
    v_mfma_f32_16x16x32_bf16 v[36:39], a[132:135], v[196:199], v[36:39]
    v_exp_f32 v180, v164
    v_mfma_f32_16x16x32_bf16 v[40:43], a[136:139], v[196:199], v[40:43]
    v_cvt_pk_bf16_f32 v192, v176, v177
    v_mfma_f32_16x16x32_bf16 v[44:47], a[140:143], v[196:199], v[44:47]
    v_exp_f32 v181, v165
    v_cvt_pk_bf16_f32 v193, v178, v179
    v_mfma_f32_16x16x32_bf16 v[48:51], a[144:147], v[196:199], v[48:51]
    ds_read_b128 a[104:107], v210
    v_exp_f32 v182, v166
    v_mfma_f32_16x16x32_bf16 v[52:55], a[148:151], v[196:199], v[52:55]
    v_exp_f32 v183, v167
    v_mfma_f32_16x16x32_bf16 v[56:59], a[152:155], v[196:199], v[56:59]
    buffer_store_dwordx4 a[208:211], v234, s[16:19], s24 offen sc0 sc1 nt
    v_mfma_f32_16x16x32_bf16 v[60:63], a[156:159], v[196:199], v[60:63]
    v_cvt_pk_bf16_f32 v194, v180, v181
    v_cvt_pk_bf16_f32 v195, v182, v183
    v_mfma_f32_16x16x32_bf16 v[128:131], a[64:67], a[0:3], 0
    v_fma_f32 v168, v136, s33, v243
    v_fma_f32 v169, v137, s33, v243
    v_mfma_f32_16x16x32_bf16 v[176:179], a[216:219], v[192:195], 0
    ds_read_b128 a[108:111], v211
    v_fma_f32 v170, v138, s33, v243
    v_mfma_f32_16x16x32_bf16 v[128:131], a[68:71], a[4:7], v[128:131]
    v_exp_f32 v184, v168
    v_fma_f32 v171, v139, s33, v243
    v_mfma_f32_16x16x32_bf16 v[128:131], a[72:75], a[8:11], v[128:131]
    v_fma_f32 v172, v140, s33, v243
    v_mfma_f32_16x16x32_bf16 v[128:131], a[76:79], a[12:15], v[128:131]
    v_exp_f32 v185, v169
    v_cmp_nge_f32 vcc, s39, v176
    v_mfma_f32_16x16x32_bf16 v[132:135], a[80:83], a[0:3], 0
    ds_read_b128 a[112:115], v208 offset:4096
    v_fma_f32 v173, v141, s33, v243
    v_mfma_f32_16x16x32_bf16 v[132:135], a[84:87], a[4:7], v[132:135]
    s_mov_b32 m0, s30
    v_fma_f32 v174, v142, s33, v243
    v_exp_f32 v186, v170
    v_mfma_f32_16x16x32_bf16 v[132:135], a[88:91], a[8:11], v[132:135]
    buffer_load_dwordx4 v229, s[4:7], s22 offen offset:1024 nt lds
    v_mfma_f32_16x16x32_bf16 v[132:135], a[92:95], a[12:15], v[132:135]
    s_cbranch_vccnz L_TRL1
L_RTL1:
    v_fma_f32 v175, v143, s33, v243
    v_add_f32 v238, v238, v176
    v_mfma_f32_16x16x32_bf16 v[136:139], a[64:67], a[16:19], 0
    v_exp_f32 v187, v171
    v_mfma_f32_16x16x32_bf16 v[136:139], a[68:71], a[20:23], v[136:139]
    ds_read_b128 a[116:119], v209 offset:4096
    v_exp_f32 v188, v172
    v_mfma_f32_16x16x32_bf16 v[136:139], a[72:75], a[24:27], v[136:139]
    ds_read_b128 a[212:215], v236 offset:4096
    v_mfma_f32_16x16x32_bf16 v[136:139], a[76:79], a[28:31], v[136:139]
    v_cvt_pk_bf16_f32 v196, v184, v185
    v_exp_f32 v189, v173
    v_mfma_f32_16x16x32_bf16 v[140:143], a[80:83], a[16:19], 0
    v_cvt_pk_bf16_f32 v197, v186, v187
    v_mfma_f32_16x16x32_bf16 v[140:143], a[84:87], a[20:23], v[140:143]
    v_exp_f32 v190, v174
    v_mfma_f32_16x16x32_bf16 v[140:143], a[88:91], a[24:27], v[140:143]
    ds_read_b128 a[120:123], v210 offset:4096
    v_exp_f32 v191, v175
    v_mfma_f32_16x16x32_bf16 v[140:143], a[92:95], a[28:31], v[140:143]
    v_cvt_pk_bf16_f32 v198, v188, v189
    v_cvt_pk_bf16_f32 v199, v190, v191
    v_mfma_f32_16x16x32_bf16 v[64:67], a[128:131], v[200:203], v[64:67]
    v_fma_f32 v160, v144, s33, v244
    v_fma_f32 v161, v145, s33, v244
    v_mfma_f32_16x16x32_bf16 v[184:187], a[216:219], v[196:199], 0
    v_fma_f32 v162, v146, s33, v244
    v_exp_f32 v176, v160
    v_mfma_f32_16x16x32_bf16 v[68:71], a[132:135], v[200:203], v[68:71]
    ds_read_b128 a[124:127], v211 offset:4096
    v_fma_f32 v163, v147, s33, v244
    v_mfma_f32_16x16x32_bf16 v[72:75], a[136:139], v[200:203], v[72:75]
    v_fma_f32 v164, v148, s33, v244
    v_exp_f32 v177, v161
    v_mfma_f32_16x16x32_bf16 v[76:79], a[140:143], v[200:203], v[76:79]
    v_fma_f32 v165, v149, s33, v244
    v_cmp_nge_f32 vcc, s39, v184
    v_mfma_f32_16x16x32_bf16 v[80:83], a[144:147], v[200:203], v[80:83]
    v_fma_f32 v166, v150, s33, v244
    v_exp_f32 v178, v162
    v_mfma_f32_16x16x32_bf16 v[84:87], a[148:151], v[200:203], v[84:87]
    s_mov_b32 m0, s30
    v_fma_f32 v167, v151, s33, v244
    v_exp_f32 v179, v163
    v_mfma_f32_16x16x32_bf16 v[88:91], a[152:155], v[200:203], v[88:91]
    buffer_load_dwordx4 v230, s[4:7], s22 offen offset:2048 nt lds
    v_mfma_f32_16x16x32_bf16 v[92:95], a[156:159], v[200:203], v[92:95]
    s_cbranch_vccnz L_TRL2
L_RTL2:
    v_add_f32 v239, v239, v184
    v_mfma_f32_16x16x32_bf16 v[96:99], a[128:131], v[204:207], v[96:99]
    ds_read_b64_tr_b16 a[128:129], v212 offset:16384
    v_exp_f32 v180, v164
    v_mfma_f32_16x16x32_bf16 v[100:103], a[132:135], v[204:207], v[100:103]
    ds_read_b64_tr_b16 a[130:131], v212 offset:20480
    v_cvt_pk_bf16_f32 v200, v176, v177
    v_mfma_f32_16x16x32_bf16 v[104:107], a[136:139], v[204:207], v[104:107]
    ds_read_b64_tr_b16 a[132:133], v213 offset:16384
    v_exp_f32 v181, v165
    v_mfma_f32_16x16x32_bf16 v[108:111], a[140:143], v[204:207], v[108:111]
    ds_read_b64_tr_b16 a[134:135], v213 offset:20480
    v_cvt_pk_bf16_f32 v201, v178, v179
    v_mfma_f32_16x16x32_bf16 v[112:115], a[144:147], v[204:207], v[112:115]
    ds_read_b64_tr_b16 a[136:137], v214 offset:16384
    v_exp_f32 v182, v166
    v_mfma_f32_16x16x32_bf16 v[116:119], a[148:151], v[204:207], v[116:119]
    ds_read_b64_tr_b16 a[138:139], v214 offset:20480
    v_exp_f32 v183, v167
    v_mfma_f32_16x16x32_bf16 v[120:123], a[152:155], v[204:207], v[120:123]
    ds_read_b64_tr_b16 a[140:141], v215 offset:16384
    v_cvt_pk_bf16_f32 v202, v180, v181
    v_mfma_f32_16x16x32_bf16 v[124:127], a[156:159], v[204:207], v[124:127]
    ds_read_b64_tr_b16 a[142:143], v215 offset:20480
    v_cvt_pk_bf16_f32 v203, v182, v183
    v_mfma_f32_16x16x32_bf16 v[144:147], a[64:67], a[32:35], 0
    ds_read_b64_tr_b16 a[144:145], v216 offset:16384
    v_fma_f32 v168, v152, s33, v245
    v_mfma_f32_16x16x32_bf16 v[176:179], a[216:219], v[200:203], 0
    ds_read_b64_tr_b16 a[146:147], v216 offset:20480
    v_fma_f32 v169, v153, s33, v245
    v_fma_f32 v170, v154, s33, v245
    v_mfma_f32_16x16x32_bf16 v[144:147], a[68:71], a[36:39], v[144:147]
    ds_read_b64_tr_b16 a[148:149], v217 offset:16384
    v_exp_f32 v184, v168
    v_mfma_f32_16x16x32_bf16 v[144:147], a[72:75], a[40:43], v[144:147]
    ds_read_b64_tr_b16 a[150:151], v217 offset:20480
    v_xor_b32 v234, 128, v234
    v_mfma_f32_16x16x32_bf16 v[144:147], a[76:79], a[44:47], v[144:147]
    ds_read_b64_tr_b16 a[152:153], v218 offset:16384
    v_cmp_nge_f32 vcc, s39, v176
    v_mfma_f32_16x16x32_bf16 v[148:151], a[80:83], a[32:35], 0
    ds_read_b64_tr_b16 a[154:155], v218 offset:20480
    v_fma_f32 v171, v155, s33, v245
    v_fma_f32 v172, v156, s33, v245
    v_mfma_f32_16x16x32_bf16 v[148:151], a[84:87], a[36:39], v[148:151]
    s_mov_b32 m0, s30
    ds_read_b64_tr_b16 a[156:157], v219 offset:16384
    v_exp_f32 v185, v169
    v_mfma_f32_16x16x32_bf16 v[148:151], a[88:91], a[40:43], v[148:151]
    buffer_load_dwordx4 v231, s[4:7], s22 offen offset:3072 nt lds
    v_mfma_f32_16x16x32_bf16 v[148:151], a[92:95], a[44:47], v[148:151]
    s_cbranch_vccnz L_TRL3
L_RTL3:
    ds_read_b64_tr_b16 a[158:159], v219 offset:20480
    v_add_f32 v240, v240, v176
    v_mfma_f32_16x16x32_bf16 v[152:155], a[64:67], a[48:51], 0
    s_mov_b32 s36, s22
    v_fma_f32 v173, v157, s33, v245
    v_fma_f32 v174, v158, s33, v245
    v_mfma_f32_16x16x32_bf16 v[152:155], a[68:71], a[52:55], v[152:155]
    s_add_u32 s22, s22, 4096
    v_exp_f32 v186, v170
    v_fma_f32 v175, v159, s33, v245
    v_mfma_f32_16x16x32_bf16 v[152:155], a[72:75], a[56:59], v[152:155]
    s_and_b32 s35, s22, 28672
    v_exp_f32 v187, v171
    v_mfma_f32_16x16x32_bf16 v[152:155], a[76:79], a[60:63], v[152:155]
    s_cselect_b32 s35, 0, 0x1ff8000
    v_exp_f32 v188, v172
    v_mfma_f32_16x16x32_bf16 v[156:159], a[80:83], a[48:51], 0
    s_add_u32 s22, s22, s35
    v_cvt_pk_bf16_f32 v204, v184, v185
    v_exp_f32 v189, v173
    v_mfma_f32_16x16x32_bf16 v[156:159], a[84:87], a[52:55], v[156:159]
    v_cvt_pk_bf16_f32 v205, v186, v187
    v_exp_f32 v190, v174
    v_mfma_f32_16x16x32_bf16 v[156:159], a[88:91], a[56:59], v[156:159]
    s_cmp_eq_u32 s29, 65536
    v_exp_f32 v191, v175
    v_mfma_f32_16x16x32_bf16 v[156:159], a[92:95], a[60:63], v[156:159]
    s_waitcnt lgkmcnt(1)
    s_cselect_b32 s31, 0xffff0000, s38
    v_cvt_pk_bf16_f32 v206, v188, v189
    v_cvt_pk_bf16_f32 v207, v190, v191
    v_mfma_f32_16x16x32_bf16 v[0:3], a[128:131], v[192:195], v[0:3]
    v_fma_f32 v160, v128, s33, v242
    v_fma_f32 v161, v129, s33, v242
    v_mfma_f32_16x16x32_bf16 v[184:187], a[216:219], v[204:207], 0
    v_fma_f32 v162, v130, s33, v242
    v_exp_f32 v176, v160
    v_mfma_f32_16x16x32_bf16 v[4:7], a[132:135], v[192:195], v[4:7]
    v_fma_f32 v163, v131, s33, v242
    v_fma_f32 v164, v132, s33, v242
    v_mfma_f32_16x16x32_bf16 v[8:11], a[136:139], v[192:195], v[8:11]
    v_exp_f32 v177, v161
    v_mfma_f32_16x16x32_bf16 v[12:15], a[140:143], v[192:195], v[12:15]
    ds_read_b128 a[64:67], v208 offset:8192
    v_cmp_nge_f32 vcc, s39, v184
    v_mfma_f32_16x16x32_bf16 v[16:19], a[144:147], v[192:195], v[16:19]
    v_fma_f32 v165, v133, s33, v242
    v_fma_f32 v166, v134, s33, v242
    v_mfma_f32_16x16x32_bf16 v[20:23], a[148:151], v[192:195], v[20:23]
    s_add_u32 m0, s30, 16384
    v_exp_f32 v178, v162
    v_fma_f32 v167, v135, s33, v242
    v_mfma_f32_16x16x32_bf16 v[24:27], a[152:155], v[192:195], v[24:27]
    s_waitcnt lgkmcnt(1)
    buffer_load_dwordx4 v232, s[8:11], s23 offen nt lds
    v_mfma_f32_16x16x32_bf16 v[28:31], a[156:159], v[192:195], v[28:31]
    s_cbranch_vccnz L_TRL4
L_RTL4:
    v_exp_f32 v179, v163
    v_add_f32 v241, v241, v184
    v_mfma_f32_16x16x32_bf16 v[32:35], a[128:131], v[196:199], v[32:35]
    ds_read_b128 a[68:71], v209 offset:8192
    v_mfma_f32_16x16x32_bf16 v[36:39], a[132:135], v[196:199], v[36:39]
    v_exp_f32 v180, v164
    v_cvt_pk_bf16_f32 v192, v176, v177
    v_mfma_f32_16x16x32_bf16 v[40:43], a[136:139], v[196:199], v[40:43]
    v_exp_f32 v181, v165
    v_mfma_f32_16x16x32_bf16 v[44:47], a[140:143], v[196:199], v[44:47]
    v_cvt_pk_bf16_f32 v193, v178, v179
    v_exp_f32 v182, v166
    v_mfma_f32_16x16x32_bf16 v[48:51], a[144:147], v[196:199], v[48:51]
    ds_read_b128 a[72:75], v210 offset:8192
    v_mfma_f32_16x16x32_bf16 v[52:55], a[148:151], v[196:199], v[52:55]
    v_exp_f32 v183, v167
    v_cvt_pk_bf16_f32 v194, v180, v181
    v_mfma_f32_16x16x32_bf16 v[56:59], a[152:155], v[196:199], v[56:59]
    buffer_store_dwordx4 a[212:215], v235, s[80:83], s24 offen offset:1024 sc0 sc1 nt
    v_mfma_f32_16x16x32_bf16 v[60:63], a[156:159], v[196:199], v[60:63]
    v_cvt_pk_bf16_f32 v195, v182, v183
    v_mfma_f32_16x16x32_bf16 v[128:131], a[96:99], a[0:3], 0
    v_fma_f32 v168, v136, s33, v243
    v_fma_f32 v169, v137, s33, v243
    v_mfma_f32_16x16x32_bf16 v[176:179], a[216:219], v[192:195], 0
    ds_read_b128 a[76:79], v211 offset:8192
    v_fma_f32 v170, v138, s33, v243
    v_mfma_f32_16x16x32_bf16 v[128:131], a[100:103], a[4:7], v[128:131]
    v_exp_f32 v184, v168
    v_fma_f32 v171, v139, s33, v243
    v_mfma_f32_16x16x32_bf16 v[128:131], a[104:107], a[8:11], v[128:131]
    v_fma_f32 v172, v140, s33, v243
    v_exp_f32 v185, v169
    v_mfma_f32_16x16x32_bf16 v[128:131], a[108:111], a[12:15], v[128:131]
    v_fma_f32 v173, v141, s33, v243
    v_cmp_nge_f32 vcc, s39, v176
    v_mfma_f32_16x16x32_bf16 v[132:135], a[112:115], a[0:3], 0
    ds_read_b128 a[80:83], v208 offset:12288
    v_fma_f32 v174, v142, s33, v243
    v_mfma_f32_16x16x32_bf16 v[132:135], a[116:119], a[4:7], v[132:135]
    s_add_u32 m0, s30, 16384
    v_exp_f32 v186, v170
    v_add_u32 v208, s31, v208
    v_mfma_f32_16x16x32_bf16 v[132:135], a[120:123], a[8:11], v[132:135]
    buffer_load_dwordx4 v233, s[8:11], s23 offen offset:1024 nt lds
    v_mfma_f32_16x16x32_bf16 v[132:135], a[124:127], a[12:15], v[132:135]
    s_cbranch_vccnz L_TRL5
L_RTL5:
    v_fma_f32 v175, v143, s33, v243
    v_add_f32 v238, v238, v176
    v_mfma_f32_16x16x32_bf16 v[136:139], a[96:99], a[16:19], 0
    s_cmp_eq_u32 s20, 38
    v_exp_f32 v187, v171
    v_exp_f32 v188, v172
    v_mfma_f32_16x16x32_bf16 v[136:139], a[100:103], a[20:23], v[136:139]
    s_cbranch_scc1 L_DEFL
L_DEFRETL:
    ds_read_b128 a[84:87], v209 offset:12288
    v_cvt_pk_bf16_f32 v196, v184, v185
    v_mfma_f32_16x16x32_bf16 v[136:139], a[104:107], a[24:27], v[136:139]
    ds_read_b128 a[208:211], v236 offset:8192
    v_add_u32 v209, s31, v209
    v_mfma_f32_16x16x32_bf16 v[136:139], a[108:111], a[28:31], v[136:139]
    v_exp_f32 v189, v173
    v_mfma_f32_16x16x32_bf16 v[140:143], a[112:115], a[16:19], 0
    v_cvt_pk_bf16_f32 v197, v186, v187
    v_exp_f32 v190, v174
    v_mfma_f32_16x16x32_bf16 v[140:143], a[116:119], a[20:23], v[140:143]
    v_exp_f32 v191, v175
    v_mfma_f32_16x16x32_bf16 v[140:143], a[120:123], a[24:27], v[140:143]
    ds_read_b128 a[88:91], v210 offset:12288
    v_cvt_pk_bf16_f32 v198, v188, v189
    v_add_u32 v236, 8192, v236
    v_mfma_f32_16x16x32_bf16 v[140:143], a[124:127], a[28:31], v[140:143]
    v_cvt_pk_bf16_f32 v199, v190, v191
    v_add_u32 v210, s31, v210
    v_mfma_f32_16x16x32_bf16 v[64:67], a[128:131], v[200:203], v[64:67]
    v_fma_f32 v160, v144, s33, v244
    v_fma_f32 v161, v145, s33, v244
    v_fma_f32 v162, v146, s33, v244
    v_mfma_f32_16x16x32_bf16 v[184:187], a[216:219], v[196:199], 0
    v_exp_f32 v176, v160
    v_mfma_f32_16x16x32_bf16 v[68:71], a[132:135], v[200:203], v[68:71]
    ds_read_b128 a[92:95], v211 offset:12288
    v_fma_f32 v163, v147, s33, v244
    v_fma_f32 v164, v148, s33, v244
    v_mfma_f32_16x16x32_bf16 v[72:75], a[136:139], v[200:203], v[72:75]
    v_exp_f32 v177, v161
    v_add_u32 v211, s31, v211
    v_mfma_f32_16x16x32_bf16 v[76:79], a[140:143], v[200:203], v[76:79]
    v_fma_f32 v165, v149, s33, v244
    v_fma_f32 v166, v150, s33, v244
    v_cmp_nge_f32 vcc, s39, v184
    v_mfma_f32_16x16x32_bf16 v[80:83], a[144:147], v[200:203], v[80:83]
    v_exp_f32 v178, v162
    v_mfma_f32_16x16x32_bf16 v[84:87], a[148:151], v[200:203], v[84:87]
    s_add_u32 m0, s30, 16384
    v_fma_f32 v167, v151, s33, v244
    v_exp_f32 v179, v163
    v_mfma_f32_16x16x32_bf16 v[88:91], a[152:155], v[200:203], v[88:91]
    buffer_load_dwordx4 v232, s[8:11], s23 offen offset:2048 nt lds
    v_mfma_f32_16x16x32_bf16 v[92:95], a[156:159], v[200:203], v[92:95]
    s_cbranch_vccnz L_TRL6
L_RTL6:
    v_exp_f32 v180, v164
    v_add_f32 v239, v239, v184
    v_mfma_f32_16x16x32_bf16 v[96:99], a[128:131], v[204:207], v[96:99]
    s_add_u32 s20, s20, 1
    ds_read_b64_tr_b16 a[128:129], v212 offset:24576
    v_cvt_pk_bf16_f32 v200, v176, v177
    v_mfma_f32_16x16x32_bf16 v[100:103], a[132:135], v[204:207], v[100:103]
    ds_read_b64_tr_b16 a[130:131], v212 offset:28672
    v_exp_f32 v181, v165
    v_mfma_f32_16x16x32_bf16 v[104:107], a[136:139], v[204:207], v[104:107]
    s_and_b32 s21, s20, 7
    ds_read_b64_tr_b16 a[132:133], v213 offset:24576
    v_cvt_pk_bf16_f32 v201, v178, v179
    v_add_u32 v212, s31, v212
    v_mfma_f32_16x16x32_bf16 v[108:111], a[140:143], v[204:207], v[108:111]
    ds_read_b64_tr_b16 a[134:135], v213 offset:28672
    v_exp_f32 v182, v166
    v_mfma_f32_16x16x32_bf16 v[112:115], a[144:147], v[204:207], v[112:115]
    ds_read_b64_tr_b16 a[136:137], v214 offset:24576
    v_add_u32 v213, s31, v213
    v_mfma_f32_16x16x32_bf16 v[116:119], a[148:151], v[204:207], v[116:119]
    ds_read_b64_tr_b16 a[138:139], v214 offset:28672
    v_exp_f32 v183, v167
    v_mfma_f32_16x16x32_bf16 v[120:123], a[152:155], v[204:207], v[120:123]
    ds_read_b64_tr_b16 a[140:141], v215 offset:24576
    v_cvt_pk_bf16_f32 v202, v180, v181
    v_add_u32 v214, s31, v214
    v_mfma_f32_16x16x32_bf16 v[124:127], a[156:159], v[204:207], v[124:127]
    ds_read_b64_tr_b16 a[142:143], v215 offset:28672
    v_cvt_pk_bf16_f32 v203, v182, v183
    v_mfma_f32_16x16x32_bf16 v[144:147], a[96:99], a[32:35], 0
    s_add_u32 s28, s28, 2048
    ds_read_b64_tr_b16 a[144:145], v216 offset:24576
    v_fma_f32 v168, v152, s33, v245
    v_add_u32 v215, s31, v215
    v_mfma_f32_16x16x32_bf16 v[176:179], a[216:219], v[200:203], 0
    s_add_u32 s25, s25, 8192
    ds_read_b64_tr_b16 a[146:147], v216 offset:28672
    v_fma_f32 v169, v153, s33, v245
    v_fma_f32 v170, v154, s33, v245
    v_mfma_f32_16x16x32_bf16 v[144:147], a[100:103], a[36:39], v[144:147]
    s_xor_b32 s24, s28, s27
    ds_read_b64_tr_b16 a[148:149], v217 offset:24576
    v_add_u32 v216, s31, v216
    v_mfma_f32_16x16x32_bf16 v[144:147], a[104:107], a[40:43], v[144:147]
    ds_read_b64_tr_b16 a[150:151], v217 offset:28672
    v_exp_f32 v184, v168
    v_xor_b32 v235, 128, v235
    v_mfma_f32_16x16x32_bf16 v[144:147], a[108:111], a[44:47], v[144:147]
    ds_read_b64_tr_b16 a[152:153], v218 offset:24576
    v_cmp_nge_f32 vcc, s39, v176
    v_add_u32 v217, s31, v217
    v_mfma_f32_16x16x32_bf16 v[148:151], a[112:115], a[32:35], 0
    ds_read_b64_tr_b16 a[154:155], v218 offset:28672
    v_fma_f32 v171, v155, s33, v245
    v_mfma_f32_16x16x32_bf16 v[148:151], a[116:119], a[36:39], v[148:151]
    s_add_u32 m0, s30, 16384
    ds_read_b64_tr_b16 a[156:157], v219 offset:24576
    v_fma_f32 v172, v156, s33, v245
    v_add_u32 v218, s31, v218
    v_mfma_f32_16x16x32_bf16 v[148:151], a[120:123], a[40:43], v[148:151]
    buffer_load_dwordx4 v233, s[8:11], s23 offen offset:3072 nt lds
    v_mfma_f32_16x16x32_bf16 v[148:151], a[124:127], a[44:47], v[148:151]
    s_add_u32 s30, s29, s32
    ds_read_b64_tr_b16 a[158:159], v219 offset:28672
    v_exp_f32 v185, v169
    v_mfma_f32_16x16x32_bf16 v[152:155], a[96:99], a[48:51], 0
    s_mov_b32 s23, s36
    v_fma_f32 v173, v157, s33, v245
    v_add_u32 v219, s31, v219
    v_mfma_f32_16x16x32_bf16 v[152:155], a[100:103], a[52:55], v[152:155]
    s_add_u32 s29, s29, s31
    v_fma_f32 v174, v158, s33, v245
    v_exp_f32 v186, v170
    v_mfma_f32_16x16x32_bf16 v[152:155], a[104:107], a[56:59], v[152:155]
    s_cbranch_vccnz L_TRL7
L_RTL7:
    v_fma_f32 v175, v159, s33, v245
    v_add_f32 v240, v240, v176
    v_mfma_f32_16x16x32_bf16 v[152:155], a[108:111], a[60:63], v[152:155]
    v_exp_f32 v187, v171
    v_exp_f32 v188, v172
    v_mfma_f32_16x16x32_bf16 v[156:159], a[112:115], a[48:51], 0
    v_cvt_pk_bf16_f32 v204, v184, v185
    v_exp_f32 v189, v173
    v_mfma_f32_16x16x32_bf16 v[156:159], a[116:119], a[52:55], v[156:159]
    v_cvt_pk_bf16_f32 v205, v186, v187
    v_mfma_f32_16x16x32_bf16 v[156:159], a[120:123], a[56:59], v[156:159]
    s_waitcnt vmcnt(8)
    v_exp_f32 v190, v174
    v_exp_f32 v191, v175
    v_mfma_f32_16x16x32_bf16 v[156:159], a[124:127], a[60:63], v[156:159]
    s_waitcnt lgkmcnt(1)
    s_cmp_lg_u32 s21, 7
    v_cvt_pk_bf16_f32 v206, v188, v189
    v_cvt_pk_bf16_f32 v207, v190, v191
    s_cbranch_scc1 L_TOPL
L_TOPF:
    v_mfma_f32_16x16x32_bf16 v[0:3], a[128:131], v[192:195], v[0:3]
    s_waitcnt lgkmcnt(0)
    v_fma_f32 v160, v128, s33, v242
    v_fma_f32 v161, v129, s33, v242
    v_fma_f32 v162, v130, s33, v242
    v_mfma_f32_16x16x32_bf16 v[184:187], a[216:219], v[204:207], 0
    v_exp_f32 v176, v160
    v_mfma_f32_16x16x32_bf16 v[4:7], a[132:135], v[192:195], v[4:7]
    v_fma_f32 v163, v131, s33, v242
    v_fma_f32 v164, v132, s33, v242
    v_mfma_f32_16x16x32_bf16 v[8:11], a[136:139], v[192:195], v[8:11]
    s_barrier
    s_add_u32 s76, s76, 16777216
    v_mfma_f32_16x16x32_bf16 v[12:15], a[140:143], v[192:195], v[12:15]
    s_addc_u32 s77, s77, 0
    ds_read_b64_tr_b16 a[96:97], v212 offset:16384
    v_exp_f32 v177, v161
    v_cmp_nge_f32 vcc, s39, v184
    v_mfma_f32_16x16x32_bf16 v[16:19], a[144:147], v[192:195], v[16:19]
    v_fma_f32 v165, v133, s33, v242
    v_fma_f32 v166, v134, s33, v242
    v_mfma_f32_16x16x32_bf16 v[20:23], a[148:151], v[192:195], v[20:23]
    s_mov_b32 s25, 4096
    ds_read_b64_tr_b16 a[98:99], v212 offset:20480
    v_exp_f32 v178, v162
    v_mfma_f32_16x16x32_bf16 v[24:27], a[152:155], v[192:195], v[24:27]
    buffer_store_dwordx4 a[160:163], v229, s[76:79], s25 offen offset:1024 sc0 sc1 nt
    v_mfma_f32_16x16x32_bf16 v[28:31], a[156:159], v[192:195], v[28:31]
    s_cbranch_vccnz L_TRF0
L_RTF0:
    v_fma_f32 v167, v135, s33, v242
    v_add_f32 v241, v241, v184
    v_mfma_f32_16x16x32_bf16 v[32:35], a[128:131], v[196:199], v[32:35]
    v_exp_f32 v179, v163
    v_mfma_f32_16x16x32_bf16 v[36:39], a[132:135], v[196:199], v[36:39]
    ds_read_b64_tr_b16 a[100:101], v213 offset:16384
    v_exp_f32 v180, v164
    v_mfma_f32_16x16x32_bf16 v[40:43], a[136:139], v[196:199], v[40:43]
    buffer_store_dwordx4 a[192:195], v228, s[16:19], s27 offen sc0 sc1 nt
    v_mfma_f32_16x16x32_bf16 v[44:47], a[140:143], v[196:199], v[44:47]
    v_cvt_pk_bf16_f32 v192, v176, v177
    v_exp_f32 v181, v165
    v_mfma_f32_16x16x32_bf16 v[48:51], a[144:147], v[196:199], v[48:51]
    ds_read_b64_tr_b16 a[102:103], v213 offset:20480
    v_cvt_pk_bf16_f32 v193, v178, v179
    v_mfma_f32_16x16x32_bf16 v[52:55], a[148:151], v[196:199], v[52:55]
    v_exp_f32 v182, v166
    v_mfma_f32_16x16x32_bf16 v[56:59], a[152:155], v[196:199], v[56:59]
    v_exp_f32 v183, v167
    v_cvt_pk_bf16_f32 v194, v180, v181
    v_mfma_f32_16x16x32_bf16 v[60:63], a[156:159], v[196:199], v[60:63]
    ds_read_b64_tr_b16 a[104:105], v214 offset:16384
    v_cvt_pk_bf16_f32 v195, v182, v183
    v_mfma_f32_16x16x32_bf16 v[128:131], a[64:67], a[0:3], 0
    v_fma_f32 v168, v136, s33, v243
    v_fma_f32 v169, v137, s33, v243
    v_mfma_f32_16x16x32_bf16 v[176:179], a[216:219], v[192:195], 0
    ds_read_b64_tr_b16 a[106:107], v214 offset:20480
    v_fma_f32 v170, v138, s33, v243
    v_mfma_f32_16x16x32_bf16 v[128:131], a[68:71], a[4:7], v[128:131]
    s_mov_b32 s25, 4096
    v_exp_f32 v184, v168
    v_fma_f32 v171, v139, s33, v243
    v_mfma_f32_16x16x32_bf16 v[128:131], a[72:75], a[8:11], v[128:131]
    buffer_store_dwordx4 a[164:167], v231, s[76:79], s25 offen offset:3072 sc0 sc1 nt
    v_mfma_f32_16x16x32_bf16 v[128:131], a[76:79], a[12:15], v[128:131]
    v_fma_f32 v172, v140, s33, v243
    v_cmp_nge_f32 vcc, s39, v176
    v_mfma_f32_16x16x32_bf16 v[132:135], a[80:83], a[0:3], 0
    ds_read_b64_tr_b16 a[108:109], v215 offset:16384
    v_exp_f32 v185, v169
    v_mfma_f32_16x16x32_bf16 v[132:135], a[84:87], a[4:7], v[132:135]
    s_cbranch_vccnz L_TRF1
L_RTF1:
    v_fma_f32 v173, v141, s33, v243
    v_fma_f32 v174, v142, s33, v243
    v_add_f32 v238, v238, v176
    v_mfma_f32_16x16x32_bf16 v[132:135], a[88:91], a[8:11], v[132:135]
    ds_read_b64_tr_b16 a[110:111], v215 offset:20480
    v_exp_f32 v186, v170
    v_mfma_f32_16x16x32_bf16 v[132:135], a[92:95], a[12:15], v[132:135]
    v_fma_f32 v175, v143, s33, v243
    v_mfma_f32_16x16x32_bf16 v[136:139], a[64:67], a[16:19], 0
    v_exp_f32 v187, v171
    v_exp_f32 v188, v172
    v_mfma_f32_16x16x32_bf16 v[136:139], a[68:71], a[20:23], v[136:139]
    ds_read_b64_tr_b16 a[112:113], v216 offset:16384
    v_cvt_pk_bf16_f32 v196, v184, v185
    v_mfma_f32_16x16x32_bf16 v[136:139], a[72:75], a[24:27], v[136:139]
    buffer_store_dwordx4 a[196:199], v229, s[16:19], s27 offen offset:1024 sc0 sc1 nt
    v_mfma_f32_16x16x32_bf16 v[136:139], a[76:79], a[28:31], v[136:139]
    v_exp_f32 v189, v173
    v_mfma_f32_16x16x32_bf16 v[140:143], a[80:83], a[16:19], 0
    ds_read_b64_tr_b16 a[114:115], v216 offset:20480
    v_cvt_pk_bf16_f32 v197, v186, v187
    v_mfma_f32_16x16x32_bf16 v[140:143], a[84:87], a[20:23], v[140:143]
    v_exp_f32 v190, v174
    v_mfma_f32_16x16x32_bf16 v[140:143], a[88:91], a[24:27], v[140:143]
    v_exp_f32 v191, v175
    v_cvt_pk_bf16_f32 v198, v188, v189
    v_mfma_f32_16x16x32_bf16 v[140:143], a[92:95], a[28:31], v[140:143]
    ds_read_b64_tr_b16 a[116:117], v217 offset:16384
    v_cvt_pk_bf16_f32 v199, v190, v191
    v_mfma_f32_16x16x32_bf16 v[64:67], a[128:131], v[200:203], v[64:67]
    v_fma_f32 v160, v144, s33, v244
    v_fma_f32 v161, v145, s33, v244
    v_mfma_f32_16x16x32_bf16 v[184:187], a[216:219], v[196:199], 0
    ds_read_b64_tr_b16 a[118:119], v217 offset:20480
    v_fma_f32 v162, v146, s33, v244
    v_mfma_f32_16x16x32_bf16 v[68:71], a[132:135], v[200:203], v[68:71]
    s_mov_b32 s25, 8192
    v_exp_f32 v176, v160
    v_fma_f32 v163, v147, s33, v244
    v_mfma_f32_16x16x32_bf16 v[72:75], a[136:139], v[200:203], v[72:75]
    buffer_store_dwordx4 a[168:171], v229, s[76:79], s25 offen offset:1024 sc0 sc1 nt
    v_mfma_f32_16x16x32_bf16 v[76:79], a[140:143], v[200:203], v[76:79]
    v_fma_f32 v164, v148, s33, v244
    v_cmp_nge_f32 vcc, s39, v184
    v_mfma_f32_16x16x32_bf16 v[80:83], a[144:147], v[200:203], v[80:83]
    ds_read_b64_tr_b16 a[120:121], v218 offset:16384
    v_exp_f32 v177, v161
    v_mfma_f32_16x16x32_bf16 v[84:87], a[148:151], v[200:203], v[84:87]
    s_cbranch_vccnz L_TRF2
L_RTF2:
    v_fma_f32 v165, v149, s33, v244
    v_add_f32 v239, v239, v184
    v_mfma_f32_16x16x32_bf16 v[88:91], a[152:155], v[200:203], v[88:91]
    ds_read_b64_tr_b16 a[122:123], v218 offset:20480
    v_fma_f32 v166, v150, s33, v244
    v_mfma_f32_16x16x32_bf16 v[92:95], a[156:159], v[200:203], v[92:95]
    v_exp_f32 v178, v162
    v_fma_f32 v167, v151, s33, v244
    v_mfma_f32_16x16x32_bf16 v[96:99], a[128:131], v[204:207], v[96:99]
    v_exp_f32 v179, v163
    v_mfma_f32_16x16x32_bf16 v[100:103], a[132:135], v[204:207], v[100:103]
    ds_read_b64_tr_b16 a[124:125], v219 offset:16384
    v_exp_f32 v180, v164
    v_mfma_f32_16x16x32_bf16 v[104:107], a[136:139], v[204:207], v[104:107]
    buffer_store_dwordx4 a[200:203], v230, s[16:19], s27 offen offset:2048 sc0 sc1 nt
    v_mfma_f32_16x16x32_bf16 v[108:111], a[140:143], v[204:207], v[108:111]
    v_cvt_pk_bf16_f32 v200, v176, v177
    v_mfma_f32_16x16x32_bf16 v[112:115], a[144:147], v[204:207], v[112:115]
    ds_read_b64_tr_b16 a[126:127], v219 offset:20480
    v_exp_f32 v181, v165
    v_mfma_f32_16x16x32_bf16 v[116:119], a[148:151], v[204:207], v[116:119]
    v_cvt_pk_bf16_f32 v201, v178, v179
    v_exp_f32 v182, v166
    v_mfma_f32_16x16x32_bf16 v[120:123], a[152:155], v[204:207], v[120:123]
    v_exp_f32 v183, v167
    v_mfma_f32_16x16x32_bf16 v[124:127], a[156:159], v[204:207], v[124:127]
    v_cvt_pk_bf16_f32 v202, v180, v181
    v_cvt_pk_bf16_f32 v203, v182, v183
    v_mfma_f32_16x16x32_bf16 v[144:147], a[64:67], a[32:35], 0
    ds_read_b64_tr_b16 a[128:129], v212 offset:24576
    v_fma_f32 v168, v152, s33, v245
    v_fma_f32 v169, v153, s33, v245
    v_mfma_f32_16x16x32_bf16 v[176:179], a[216:219], v[200:203], 0
    v_fma_f32 v170, v154, s33, v245
    v_exp_f32 v184, v168
    v_mfma_f32_16x16x32_bf16 v[144:147], a[68:71], a[36:39], v[144:147]
    s_mov_b32 s25, 8192
    ds_read_b64_tr_b16 a[130:131], v212 offset:28672
    v_fma_f32 v171, v155, s33, v245
    v_mfma_f32_16x16x32_bf16 v[144:147], a[72:75], a[40:43], v[144:147]
    buffer_store_dwordx4 a[172:175], v231, s[76:79], s25 offen offset:3072 sc0 sc1 nt
    v_mfma_f32_16x16x32_bf16 v[144:147], a[76:79], a[44:47], v[144:147]
    v_fma_f32 v172, v156, s33, v245
    v_cmp_nge_f32 vcc, s39, v176
    v_mfma_f32_16x16x32_bf16 v[148:151], a[80:83], a[32:35], 0
    ds_read_b64_tr_b16 a[132:133], v213 offset:24576
    v_exp_f32 v185, v169
    v_mfma_f32_16x16x32_bf16 v[148:151], a[84:87], a[36:39], v[148:151]
    s_cbranch_vccnz L_TRF3
L_RTF3:
    v_fma_f32 v173, v157, s33, v245
    v_add_f32 v240, v240, v176
    v_mfma_f32_16x16x32_bf16 v[148:151], a[88:91], a[40:43], v[148:151]
    ds_read_b64_tr_b16 a[134:135], v213 offset:28672
    v_fma_f32 v174, v158, s33, v245
    v_mfma_f32_16x16x32_bf16 v[148:151], a[92:95], a[44:47], v[148:151]
    v_exp_f32 v186, v170
    v_fma_f32 v175, v159, s33, v245
    v_mfma_f32_16x16x32_bf16 v[152:155], a[64:67], a[48:51], 0
    v_exp_f32 v187, v171
    v_mfma_f32_16x16x32_bf16 v[152:155], a[68:71], a[52:55], v[152:155]
    ds_read_b64_tr_b16 a[136:137], v214 offset:24576
    v_exp_f32 v188, v172
    v_mfma_f32_16x16x32_bf16 v[152:155], a[72:75], a[56:59], v[152:155]
    buffer_store_dwordx4 a[204:207], v231, s[16:19], s27 offen offset:3072 sc0 sc1 nt
    v_mfma_f32_16x16x32_bf16 v[152:155], a[76:79], a[60:63], v[152:155]
    v_cvt_pk_bf16_f32 v204, v184, v185
    v_exp_f32 v189, v173
    v_mfma_f32_16x16x32_bf16 v[156:159], a[80:83], a[48:51], 0
    ds_read_b64_tr_b16 a[138:139], v214 offset:28672
    v_cvt_pk_bf16_f32 v205, v186, v187
    v_mfma_f32_16x16x32_bf16 v[156:159], a[84:87], a[52:55], v[156:159]
    v_exp_f32 v190, v174
    v_mfma_f32_16x16x32_bf16 v[156:159], a[88:91], a[56:59], v[156:159]
    ds_read_b64_tr_b16 a[140:141], v215 offset:24576
    v_exp_f32 v191, v175
    v_mfma_f32_16x16x32_bf16 v[156:159], a[92:95], a[60:63], v[156:159]
    s_waitcnt lgkmcnt(4)
    v_cvt_pk_bf16_f32 v206, v188, v189
    v_cvt_pk_bf16_f32 v207, v190, v191
    v_mfma_f32_16x16x32_bf16 v[0:3], a[96:99], v[192:195], v[0:3]
    v_fma_f32 v160, v128, s33, v242
    v_fma_f32 v161, v129, s33, v242
    v_mfma_f32_16x16x32_bf16 v[184:187], a[216:219], v[204:207], 0
    ds_read_b64_tr_b16 a[142:143], v215 offset:28672
    v_fma_f32 v162, v130, s33, v242
    v_mfma_f32_16x16x32_bf16 v[4:7], a[100:103], v[192:195], v[4:7]
    s_mov_b32 s25, 12288
    v_exp_f32 v176, v160
    v_fma_f32 v163, v131, s33, v242
    v_mfma_f32_16x16x32_bf16 v[8:11], a[104:107], v[192:195], v[8:11]
    buffer_store_dwordx4 a[176:179], v229, s[76:79], s25 offen offset:1024 sc0 sc1 nt
    v_mfma_f32_16x16x32_bf16 v[12:15], a[108:111], v[192:195], v[12:15]
    ds_read_b64_tr_b16 a[144:145], v216 offset:24576
    v_fma_f32 v164, v132, s33, v242
    v_cmp_nge_f32 vcc, s39, v184
    v_mfma_f32_16x16x32_bf16 v[16:19], a[112:115], v[192:195], v[16:19]
    v_exp_f32 v177, v161
    v_mfma_f32_16x16x32_bf16 v[20:23], a[116:119], v[192:195], v[20:23]
    s_cbranch_vccnz L_TRF4
L_RTF4:
    ds_read_b64_tr_b16 a[146:147], v216 offset:28672
    v_fma_f32 v165, v133, s33, v242
    v_add_f32 v241, v241, v184
    v_mfma_f32_16x16x32_bf16 v[24:27], a[120:123], v[192:195], v[24:27]
    v_fma_f32 v166, v134, s33, v242
    v_exp_f32 v178, v162
    v_mfma_f32_16x16x32_bf16 v[28:31], a[124:127], v[192:195], v[28:31]
    v_fma_f32 v167, v135, s33, v242
    v_mfma_f32_16x16x32_bf16 v[32:35], a[96:99], v[196:199], v[32:35]
    ds_read_b64_tr_b16 a[148:149], v217 offset:24576
    v_exp_f32 v179, v163
    v_mfma_f32_16x16x32_bf16 v[36:39], a[100:103], v[196:199], v[36:39]
    s_mov_b32 s25, 12288
    v_exp_f32 v180, v164
    v_cvt_pk_bf16_f32 v192, v176, v177
    v_mfma_f32_16x16x32_bf16 v[40:43], a[104:107], v[196:199], v[40:43]
    buffer_store_dwordx4 a[180:183], v231, s[76:79], s25 offen offset:3072 sc0 sc1 nt
    v_mfma_f32_16x16x32_bf16 v[44:47], a[108:111], v[196:199], v[44:47]
    ds_read_b64_tr_b16 a[150:151], v217 offset:28672
    v_mfma_f32_16x16x32_bf16 v[48:51], a[112:115], v[196:199], v[48:51]
    v_exp_f32 v181, v165
    v_cvt_pk_bf16_f32 v193, v178, v179
    v_mfma_f32_16x16x32_bf16 v[52:55], a[116:119], v[196:199], v[52:55]
    ds_read_b64_tr_b16 a[152:153], v218 offset:24576
    v_exp_f32 v182, v166
    v_mfma_f32_16x16x32_bf16 v[56:59], a[120:123], v[196:199], v[56:59]
    v_exp_f32 v183, v167
    v_mfma_f32_16x16x32_bf16 v[60:63], a[124:127], v[196:199], v[60:63]
    v_cvt_pk_bf16_f32 v194, v180, v181
    v_cvt_pk_bf16_f32 v195, v182, v183
    v_mfma_f32_16x16x32_bf16 v[64:67], a[96:99], v[200:203], v[64:67]
    s_add_u32 s16, s16, 16777216
    ds_read_b64_tr_b16 a[154:155], v218 offset:28672
    v_fma_f32 v168, v136, s33, v243
    v_mfma_f32_16x16x32_bf16 v[176:179], a[216:219], v[192:195], 0
    s_addc_u32 s17, s17, 0
    v_fma_f32 v169, v137, s33, v243
    v_fma_f32 v170, v138, s33, v243
    v_mfma_f32_16x16x32_bf16 v[68:71], a[100:103], v[200:203], v[68:71]
    ds_read_b64_tr_b16 a[156:157], v219 offset:24576
    v_mfma_f32_16x16x32_bf16 v[72:75], a[104:107], v[200:203], v[72:75]
    v_exp_f32 v184, v168
    v_fma_f32 v171, v139, s33, v243
    v_mfma_f32_16x16x32_bf16 v[76:79], a[108:111], v[200:203], v[76:79]
    ds_read_b64_tr_b16 a[158:159], v219 offset:28672
    v_cmp_nge_f32 vcc, s39, v176
    v_mfma_f32_16x16x32_bf16 v[80:83], a[112:115], v[200:203], v[80:83]
    v_fma_f32 v172, v140, s33, v243
    v_mfma_f32_16x16x32_bf16 v[84:87], a[116:119], v[200:203], v[84:87]
    s_cbranch_vccnz L_TRF5
L_RTF5:
    v_exp_f32 v185, v169
    v_add_f32 v238, v238, v176
    v_mfma_f32_16x16x32_bf16 v[88:91], a[120:123], v[200:203], v[88:91]
    v_fma_f32 v173, v141, s33, v243
    v_fma_f32 v174, v142, s33, v243
    v_mfma_f32_16x16x32_bf16 v[92:95], a[124:127], v[200:203], v[92:95]
    v_exp_f32 v186, v170
    v_mfma_f32_16x16x32_bf16 v[96:99], a[96:99], v[204:207], v[96:99]
    v_fma_f32 v175, v143, s33, v243
    v_mfma_f32_16x16x32_bf16 v[100:103], a[100:103], v[204:207], v[100:103]
    v_exp_f32 v187, v171
    v_mfma_f32_16x16x32_bf16 v[104:107], a[104:107], v[204:207], v[104:107]
    v_exp_f32 v188, v172
    v_mfma_f32_16x16x32_bf16 v[108:111], a[108:111], v[204:207], v[108:111]
    v_cvt_pk_bf16_f32 v196, v184, v185
    v_exp_f32 v189, v173
    v_mfma_f32_16x16x32_bf16 v[112:115], a[112:115], v[204:207], v[112:115]
    v_cvt_pk_bf16_f32 v197, v186, v187
    v_mfma_f32_16x16x32_bf16 v[116:119], a[116:119], v[204:207], v[116:119]
    v_exp_f32 v190, v174
    v_mfma_f32_16x16x32_bf16 v[120:123], a[120:123], v[204:207], v[120:123]
    v_exp_f32 v191, v175
    v_mfma_f32_16x16x32_bf16 v[124:127], a[124:127], v[204:207], v[124:127]
    v_cvt_pk_bf16_f32 v198, v188, v189
    v_cvt_pk_bf16_f32 v199, v190, v191
    v_mfma_f32_16x16x32_bf16 v[0:3], a[128:131], v[192:195], v[0:3]
    v_fma_f32 v160, v144, s33, v244
    v_fma_f32 v161, v145, s33, v244
    v_mfma_f32_16x16x32_bf16 v[184:187], a[216:219], v[196:199], 0
    s_waitcnt lgkmcnt(0)
    v_fma_f32 v162, v146, s33, v244
    v_exp_f32 v176, v160
    v_mfma_f32_16x16x32_bf16 v[4:7], a[132:135], v[192:195], v[4:7]
    v_fma_f32 v163, v147, s33, v244
    v_mfma_f32_16x16x32_bf16 v[8:11], a[136:139], v[192:195], v[8:11]
    v_fma_f32 v164, v148, s33, v244
    v_exp_f32 v177, v161
    v_mfma_f32_16x16x32_bf16 v[12:15], a[140:143], v[192:195], v[12:15]
    v_cmp_nge_f32 vcc, s39, v184
    v_mfma_f32_16x16x32_bf16 v[16:19], a[144:147], v[192:195], v[16:19]
    v_fma_f32 v165, v149, s33, v244
    v_fma_f32 v166, v150, s33, v244
    v_mfma_f32_16x16x32_bf16 v[20:23], a[148:151], v[192:195], v[20:23]
    s_cbranch_vccnz L_TRF6
L_RTF6:
    v_exp_f32 v178, v162
    v_add_f32 v239, v239, v184
    v_mfma_f32_16x16x32_bf16 v[24:27], a[152:155], v[192:195], v[24:27]
    v_fma_f32 v167, v151, s33, v244
    v_mfma_f32_16x16x32_bf16 v[28:31], a[156:159], v[192:195], v[28:31]
    v_exp_f32 v179, v163
    v_mfma_f32_16x16x32_bf16 v[32:35], a[128:131], v[196:199], v[32:35]
    v_exp_f32 v180, v164
    v_mfma_f32_16x16x32_bf16 v[36:39], a[132:135], v[196:199], v[36:39]
    v_cvt_pk_bf16_f32 v200, v176, v177
    v_exp_f32 v181, v165
    v_mfma_f32_16x16x32_bf16 v[40:43], a[136:139], v[196:199], v[40:43]
    v_rcp_f32 v250, v238
    v_mfma_f32_16x16x32_bf16 v[44:47], a[140:143], v[196:199], v[44:47]
    v_cvt_pk_bf16_f32 v201, v178, v179
    v_mfma_f32_16x16x32_bf16 v[48:51], a[144:147], v[196:199], v[48:51]
    v_rcp_f32 v252, v239
    v_mfma_f32_16x16x32_bf16 v[52:55], a[148:151], v[196:199], v[52:55]
    v_exp_f32 v182, v166
    v_mfma_f32_16x16x32_bf16 v[56:59], a[152:155], v[196:199], v[56:59]
    v_exp_f32 v183, v167
    v_mfma_f32_16x16x32_bf16 v[60:63], a[156:159], v[196:199], v[60:63]
    v_cvt_pk_bf16_f32 v202, v180, v181
    v_cvt_pk_bf16_f32 v203, v182, v183
L_TAIL:
    v_pk_mul_f32 v[0:1], v[0:1], v[250:251] op_sel_hi:[1,0]
    v_pk_mul_f32 v[2:3], v[2:3], v[250:251] op_sel_hi:[1,0]
    v_pk_mul_f32 v[4:5], v[4:5], v[250:251] op_sel_hi:[1,0]
    v_pk_mul_f32 v[6:7], v[6:7], v[250:251] op_sel_hi:[1,0]
    v_pk_mul_f32 v[8:9], v[8:9], v[250:251] op_sel_hi:[1,0]
    v_pk_mul_f32 v[10:11], v[10:11], v[250:251] op_sel_hi:[1,0]
    v_pk_mul_f32 v[12:13], v[12:13], v[250:251] op_sel_hi:[1,0]
    v_pk_mul_f32 v[14:15], v[14:15], v[250:251] op_sel_hi:[1,0]
    v_pk_mul_f32 v[16:17], v[16:17], v[250:251] op_sel_hi:[1,0]
    v_pk_mul_f32 v[18:19], v[18:19], v[250:251] op_sel_hi:[1,0]
    v_pk_mul_f32 v[20:21], v[20:21], v[250:251] op_sel_hi:[1,0]
    v_pk_mul_f32 v[22:23], v[22:23], v[250:251] op_sel_hi:[1,0]
    v_pk_mul_f32 v[24:25], v[24:25], v[250:251] op_sel_hi:[1,0]
    v_pk_mul_f32 v[26:27], v[26:27], v[250:251] op_sel_hi:[1,0]
    v_pk_mul_f32 v[28:29], v[28:29], v[250:251] op_sel_hi:[1,0]
    v_pk_mul_f32 v[30:31], v[30:31], v[250:251] op_sel_hi:[1,0]
    v_pk_mul_f32 v[32:33], v[32:33], v[252:253] op_sel_hi:[1,0]
    v_pk_mul_f32 v[34:35], v[34:35], v[252:253] op_sel_hi:[1,0]
    v_pk_mul_f32 v[36:37], v[36:37], v[252:253] op_sel_hi:[1,0]
    v_pk_mul_f32 v[38:39], v[38:39], v[252:253] op_sel_hi:[1,0]
    v_pk_mul_f32 v[40:41], v[40:41], v[252:253] op_sel_hi:[1,0]
    v_pk_mul_f32 v[42:43], v[42:43], v[252:253] op_sel_hi:[1,0]
    v_pk_mul_f32 v[44:45], v[44:45], v[252:253] op_sel_hi:[1,0]
    v_pk_mul_f32 v[46:47], v[46:47], v[252:253] op_sel_hi:[1,0]
    v_pk_mul_f32 v[48:49], v[48:49], v[252:253] op_sel_hi:[1,0]
    v_pk_mul_f32 v[50:51], v[50:51], v[252:253] op_sel_hi:[1,0]
    v_pk_mul_f32 v[52:53], v[52:53], v[252:253] op_sel_hi:[1,0]
    v_pk_mul_f32 v[54:55], v[54:55], v[252:253] op_sel_hi:[1,0]
    v_pk_mul_f32 v[56:57], v[56:57], v[252:253] op_sel_hi:[1,0]
    v_pk_mul_f32 v[58:59], v[58:59], v[252:253] op_sel_hi:[1,0]
    v_pk_mul_f32 v[60:61], v[60:61], v[252:253] op_sel_hi:[1,0]
    v_pk_mul_f32 v[62:63], v[62:63], v[252:253] op_sel_hi:[1,0]
    v_fma_f32 v168, v152, s33, v245
    v_fma_f32 v169, v153, s33, v245
    v_mfma_f32_16x16x32_bf16 v[176:179], a[216:219], v[200:203], 0
    v_fma_f32 v170, v154, s33, v245
    v_fma_f32 v171, v155, s33, v245
    v_fma_f32 v172, v156, s33, v245
    v_fma_f32 v173, v157, s33, v245
    v_fma_f32 v174, v158, s33, v245
    v_fma_f32 v175, v159, s33, v245
    v_exp_f32 v184, v168
    v_exp_f32 v185, v169
    v_cmp_nge_f32 vcc, s39, v176
    v_exp_f32 v186, v170
    v_exp_f32 v187, v171
    v_exp_f32 v188, v172
    s_cbranch_vccnz L_TRT0
L_RTT0:
    v_add_f32 v240, v240, v176
    v_mfma_f32_16x16x32_bf16 v[64:67], a[128:131], v[200:203], v[64:67]
    v_exp_f32 v189, v173
    v_mfma_f32_16x16x32_bf16 v[68:71], a[132:135], v[200:203], v[68:71]
    v_exp_f32 v190, v174
    v_mfma_f32_16x16x32_bf16 v[72:75], a[136:139], v[200:203], v[72:75]
    v_exp_f32 v191, v175
    v_mfma_f32_16x16x32_bf16 v[76:79], a[140:143], v[200:203], v[76:79]
    v_cvt_pk_bf16_f32 v204, v184, v185
    v_mfma_f32_16x16x32_bf16 v[80:83], a[144:147], v[200:203], v[80:83]
    v_cvt_pk_bf16_f32 v205, v186, v187
    v_mfma_f32_16x16x32_bf16 v[84:87], a[148:151], v[200:203], v[84:87]
    v_cvt_pk_bf16_f32 v206, v188, v189
    v_mfma_f32_16x16x32_bf16 v[88:91], a[152:155], v[200:203], v[88:91]
    v_cvt_pk_bf16_f32 v207, v190, v191
    v_mfma_f32_16x16x32_bf16 v[92:95], a[156:159], v[200:203], v[92:95]
    s_nop 0
    v_mfma_f32_16x16x32_bf16 v[184:187], a[216:219], v[204:207], 0
    v_cvt_pk_bf16_f32 v0, v0, v1
    v_cvt_pk_bf16_f32 v1, v2, v3
    v_cvt_pk_bf16_f32 v32, v32, v33
    v_cvt_pk_bf16_f32 v33, v34, v35
    ds_write_b64 v220, v[0:1]
    ds_write_b64 v220, v[32:33] offset:16384
    v_cvt_pk_bf16_f32 v4, v4, v5
    v_cvt_pk_bf16_f32 v5, v6, v7
    v_cvt_pk_bf16_f32 v36, v36, v37
    v_cvt_pk_bf16_f32 v37, v38, v39
    v_cmp_nge_f32 vcc, s39, v184
    ds_write_b64 v221, v[4:5]
    ds_write_b64 v221, v[36:37] offset:16384
    v_cvt_pk_bf16_f32 v8, v8, v9
    v_cvt_pk_bf16_f32 v9, v10, v11
    v_cvt_pk_bf16_f32 v40, v40, v41
    v_cvt_pk_bf16_f32 v41, v42, v43
    s_cbranch_vccnz L_TRT1
L_RTT1:
    v_add_f32 v241, v241, v184
    v_mfma_f32_16x16x32_bf16 v[96:99], a[128:131], v[204:207], v[96:99]
    ds_write_b64 v222, v[8:9]
    ds_write_b64 v222, v[40:41] offset:16384
    v_cvt_pk_bf16_f32 v12, v12, v13
    v_mfma_f32_16x16x32_bf16 v[100:103], a[132:135], v[204:207], v[100:103]
    v_cvt_pk_bf16_f32 v13, v14, v15
    v_cvt_pk_bf16_f32 v44, v44, v45
    v_cvt_pk_bf16_f32 v45, v46, v47
    v_mfma_f32_16x16x32_bf16 v[104:107], a[136:139], v[204:207], v[104:107]
    ds_write_b64 v223, v[12:13]
    ds_write_b64 v223, v[44:45] offset:16384
    v_cvt_pk_bf16_f32 v16, v16, v17
    v_mfma_f32_16x16x32_bf16 v[108:111], a[140:143], v[204:207], v[108:111]
    v_cvt_pk_bf16_f32 v17, v18, v19
    v_cvt_pk_bf16_f32 v48, v48, v49
    v_cvt_pk_bf16_f32 v49, v50, v51
    v_mfma_f32_16x16x32_bf16 v[112:115], a[144:147], v[204:207], v[112:115]
    ds_write_b64 v224, v[16:17]
    ds_write_b64 v224, v[48:49] offset:16384
    v_cvt_pk_bf16_f32 v20, v20, v21
    v_mfma_f32_16x16x32_bf16 v[116:119], a[148:151], v[204:207], v[116:119]
    v_cvt_pk_bf16_f32 v21, v22, v23
    v_cvt_pk_bf16_f32 v52, v52, v53
    v_cvt_pk_bf16_f32 v53, v54, v55
    v_mfma_f32_16x16x32_bf16 v[120:123], a[152:155], v[204:207], v[120:123]
    ds_write_b64 v225, v[20:21]
    ds_write_b64 v225, v[52:53] offset:16384
    v_cvt_pk_bf16_f32 v24, v24, v25
    v_mfma_f32_16x16x32_bf16 v[124:127], a[156:159], v[204:207], v[124:127]
    v_cvt_pk_bf16_f32 v25, v26, v27
    v_cvt_pk_bf16_f32 v56, v56, v57
    v_cvt_pk_bf16_f32 v57, v58, v59
    ds_write_b64 v226, v[24:25]
    ds_write_b64 v226, v[56:57] offset:16384
    v_cvt_pk_bf16_f32 v28, v28, v29
    v_cvt_pk_bf16_f32 v29, v30, v31
    v_cvt_pk_bf16_f32 v60, v60, v61
    v_cvt_pk_bf16_f32 v61, v62, v63
    ds_write_b64 v227, v[28:29]
    ds_write_b64 v227, v[60:61] offset:16384
    ds_read_b128 a[64:67], v237
    ds_read_b128 a[68:71], v237 offset:4096
    ds_read_b128 a[72:75], v237 offset:8192
    ds_read_b128 a[76:79], v237 offset:12288
    ds_read_b128 a[80:83], v237 offset:16384
    ds_read_b128 a[84:87], v237 offset:20480
    ds_read_b128 a[88:91], v237 offset:24576
    ds_read_b128 a[92:95], v237 offset:28672
    v_rcp_f32 v250, v240
    v_rcp_f32 v252, v241
    v_pk_mul_f32 v[64:65], v[64:65], v[250:251] op_sel_hi:[1,0]
    v_pk_mul_f32 v[66:67], v[66:67], v[250:251] op_sel_hi:[1,0]
    v_pk_mul_f32 v[68:69], v[68:69], v[250:251] op_sel_hi:[1,0]
    v_pk_mul_f32 v[70:71], v[70:71], v[250:251] op_sel_hi:[1,0]
    v_pk_mul_f32 v[72:73], v[72:73], v[250:251] op_sel_hi:[1,0]
    v_pk_mul_f32 v[74:75], v[74:75], v[250:251] op_sel_hi:[1,0]
    v_pk_mul_f32 v[76:77], v[76:77], v[250:251] op_sel_hi:[1,0]
    v_pk_mul_f32 v[78:79], v[78:79], v[250:251] op_sel_hi:[1,0]
    v_pk_mul_f32 v[80:81], v[80:81], v[250:251] op_sel_hi:[1,0]
    v_pk_mul_f32 v[82:83], v[82:83], v[250:251] op_sel_hi:[1,0]
    v_pk_mul_f32 v[84:85], v[84:85], v[250:251] op_sel_hi:[1,0]
    v_pk_mul_f32 v[86:87], v[86:87], v[250:251] op_sel_hi:[1,0]
    v_pk_mul_f32 v[88:89], v[88:89], v[250:251] op_sel_hi:[1,0]
    v_pk_mul_f32 v[90:91], v[90:91], v[250:251] op_sel_hi:[1,0]
    v_pk_mul_f32 v[92:93], v[92:93], v[250:251] op_sel_hi:[1,0]
    v_pk_mul_f32 v[94:95], v[94:95], v[250:251] op_sel_hi:[1,0]
    v_pk_mul_f32 v[96:97], v[96:97], v[252:253] op_sel_hi:[1,0]
    v_pk_mul_f32 v[98:99], v[98:99], v[252:253] op_sel_hi:[1,0]
    v_pk_mul_f32 v[100:101], v[100:101], v[252:253] op_sel_hi:[1,0]
    v_pk_mul_f32 v[102:103], v[102:103], v[252:253] op_sel_hi:[1,0]
    v_pk_mul_f32 v[104:105], v[104:105], v[252:253] op_sel_hi:[1,0]
    v_pk_mul_f32 v[106:107], v[106:107], v[252:253] op_sel_hi:[1,0]
    v_pk_mul_f32 v[108:109], v[108:109], v[252:253] op_sel_hi:[1,0]
    v_pk_mul_f32 v[110:111], v[110:111], v[252:253] op_sel_hi:[1,0]
    v_pk_mul_f32 v[112:113], v[112:113], v[252:253] op_sel_hi:[1,0]
    v_pk_mul_f32 v[114:115], v[114:115], v[252:253] op_sel_hi:[1,0]
    v_pk_mul_f32 v[116:117], v[116:117], v[252:253] op_sel_hi:[1,0]
    v_pk_mul_f32 v[118:119], v[118:119], v[252:253] op_sel_hi:[1,0]
    v_pk_mul_f32 v[120:121], v[120:121], v[252:253] op_sel_hi:[1,0]
    v_pk_mul_f32 v[122:123], v[122:123], v[252:253] op_sel_hi:[1,0]
    v_pk_mul_f32 v[124:125], v[124:125], v[252:253] op_sel_hi:[1,0]
    v_pk_mul_f32 v[126:127], v[126:127], v[252:253] op_sel_hi:[1,0]
    s_waitcnt lgkmcnt(0)
    s_xor_b32 s24, s27, 0
    buffer_store_dwordx4 a[64:67], v228, s[16:19], s24 offen sc0 sc1 nt
    buffer_store_dwordx4 a[68:71], v229, s[16:19], s24 offen offset:1024 sc0 sc1 nt
    buffer_store_dwordx4 a[72:75], v230, s[16:19], s24 offen offset:2048 sc0 sc1 nt
    buffer_store_dwordx4 a[76:79], v231, s[16:19], s24 offen offset:3072 sc0 sc1 nt
    s_xor_b32 s24, s27, 4096
    buffer_store_dwordx4 a[80:83], v228, s[16:19], s24 offen sc0 sc1 nt
    buffer_store_dwordx4 a[84:87], v229, s[16:19], s24 offen offset:1024 sc0 sc1 nt
    buffer_store_dwordx4 a[88:91], v230, s[16:19], s24 offen offset:2048 sc0 sc1 nt
    buffer_store_dwordx4 a[92:95], v231, s[16:19], s24 offen offset:3072 sc0 sc1 nt
    v_cvt_pk_bf16_f32 v64, v64, v65
    v_cvt_pk_bf16_f32 v65, v66, v67
    v_cvt_pk_bf16_f32 v96, v96, v97
    v_cvt_pk_bf16_f32 v97, v98, v99
    ds_write_b64 v220, v[64:65] offset:32768
    ds_write_b64 v220, v[96:97] offset:49152
    v_cvt_pk_bf16_f32 v68, v68, v69
    v_cvt_pk_bf16_f32 v69, v70, v71
    v_cvt_pk_bf16_f32 v100, v100, v101
    v_cvt_pk_bf16_f32 v101, v102, v103
    ds_write_b64 v221, v[68:69] offset:32768
    ds_write_b64 v221, v[100:101] offset:49152
    v_cvt_pk_bf16_f32 v72, v72, v73
    v_cvt_pk_bf16_f32 v73, v74, v75
    v_cvt_pk_bf16_f32 v104, v104, v105
    v_cvt_pk_bf16_f32 v105, v106, v107
    ds_write_b64 v222, v[72:73] offset:32768
    ds_write_b64 v222, v[104:105] offset:49152
    v_cvt_pk_bf16_f32 v76, v76, v77
    v_cvt_pk_bf16_f32 v77, v78, v79
    v_cvt_pk_bf16_f32 v108, v108, v109
    v_cvt_pk_bf16_f32 v109, v110, v111
    ds_write_b64 v223, v[76:77] offset:32768
    ds_write_b64 v223, v[108:109] offset:49152
    v_cvt_pk_bf16_f32 v80, v80, v81
    v_cvt_pk_bf16_f32 v81, v82, v83
    v_cvt_pk_bf16_f32 v112, v112, v113
    v_cvt_pk_bf16_f32 v113, v114, v115
    ds_write_b64 v224, v[80:81] offset:32768
    ds_write_b64 v224, v[112:113] offset:49152
    v_cvt_pk_bf16_f32 v84, v84, v85
    v_cvt_pk_bf16_f32 v85, v86, v87
    v_cvt_pk_bf16_f32 v116, v116, v117
    v_cvt_pk_bf16_f32 v117, v118, v119
    ds_write_b64 v225, v[84:85] offset:32768
    ds_write_b64 v225, v[116:117] offset:49152
    v_cvt_pk_bf16_f32 v88, v88, v89
    v_cvt_pk_bf16_f32 v89, v90, v91
    v_cvt_pk_bf16_f32 v120, v120, v121
    v_cvt_pk_bf16_f32 v121, v122, v123
    ds_write_b64 v226, v[88:89] offset:32768
    ds_write_b64 v226, v[120:121] offset:49152
    v_cvt_pk_bf16_f32 v92, v92, v93
    v_cvt_pk_bf16_f32 v93, v94, v95
    v_cvt_pk_bf16_f32 v124, v124, v125
    v_cvt_pk_bf16_f32 v125, v126, v127
    ds_write_b64 v227, v[92:93] offset:32768
    ds_write_b64 v227, v[124:125] offset:49152
    ds_read_b128 a[96:99], v237 offset:32768
    ds_read_b128 a[100:103], v237 offset:36864
    ds_read_b128 a[104:107], v237 offset:40960
    ds_read_b128 a[108:111], v237 offset:45056
    ds_read_b128 a[112:115], v237 offset:49152
    ds_read_b128 a[116:119], v237 offset:53248
    ds_read_b128 a[120:123], v237 offset:57344
    ds_read_b128 a[124:127], v237 offset:61440
    s_xor_b32 s24, s27, 8192
    s_waitcnt lgkmcnt(7)
    buffer_store_dwordx4 a[96:99], v228, s[16:19], s24 offen sc0 sc1 nt
    s_waitcnt lgkmcnt(6)
    buffer_store_dwordx4 a[100:103], v229, s[16:19], s24 offen offset:1024 sc0 sc1 nt
    s_waitcnt lgkmcnt(5)
    buffer_store_dwordx4 a[104:107], v230, s[16:19], s24 offen offset:2048 sc0 sc1 nt
    s_waitcnt lgkmcnt(4)
    buffer_store_dwordx4 a[108:111], v231, s[16:19], s24 offen offset:3072 sc0 sc1 nt
    s_xor_b32 s24, s27, 12288
    s_waitcnt lgkmcnt(3)
    buffer_store_dwordx4 a[112:115], v228, s[16:19], s24 offen sc0 sc1 nt
    s_waitcnt lgkmcnt(2)
    buffer_store_dwordx4 a[116:119], v229, s[16:19], s24 offen offset:1024 sc0 sc1 nt
    s_waitcnt lgkmcnt(1)
    buffer_store_dwordx4 a[120:123], v230, s[16:19], s24 offen offset:2048 sc0 sc1 nt
    s_waitcnt lgkmcnt(0)
    buffer_store_dwordx4 a[124:127], v231, s[16:19], s24 offen offset:3072 sc0 sc1 nt
    s_waitcnt vmcnt(0) lgkmcnt(0)
L_END:
    s_endpgm
L_TOPN:
    v_mfma_f32_16x16x32_bf16 v[0:3], a[128:131], v[192:195], v[0:3]
    s_waitcnt lgkmcnt(0)
    v_fma_f32 v160, v128, s33, v242
    v_fma_f32 v161, v129, s33, v242
    v_mfma_f32_16x16x32_bf16 v[184:187], a[216:219], v[204:207], 0
    v_fma_f32 v162, v130, s33, v242
    v_exp_f32 v176, v160
    v_mfma_f32_16x16x32_bf16 v[4:7], a[132:135], v[192:195], v[4:7]
    v_fma_f32 v163, v131, s33, v242
    v_fma_f32 v164, v132, s33, v242
    v_mfma_f32_16x16x32_bf16 v[8:11], a[136:139], v[192:195], v[8:11]
    s_barrier
    v_mfma_f32_16x16x32_bf16 v[12:15], a[140:143], v[192:195], v[12:15]
    ds_read_b128 a[96:99], v208
    v_cmp_nge_f32 vcc, s39, v184
    v_mfma_f32_16x16x32_bf16 v[16:19], a[144:147], v[192:195], v[16:19]
    v_exp_f32 v177, v161
    v_fma_f32 v165, v133, s33, v242
    v_mfma_f32_16x16x32_bf16 v[20:23], a[148:151], v[192:195], v[20:23]
    s_mov_b32 m0, s30
    v_fma_f32 v166, v134, s33, v242
    v_exp_f32 v178, v162
    v_mfma_f32_16x16x32_bf16 v[24:27], a[152:155], v[192:195], v[24:27]
    s_waitcnt vmcnt(8)
    buffer_load_dwordx4 v228, s[4:7], s22 offen nt lds
    v_mfma_f32_16x16x32_bf16 v[28:31], a[156:159], v[192:195], v[28:31]
    s_cbranch_vccnz L_TRN0
L_RTN0:
    v_fma_f32 v167, v135, s33, v242
    v_add_f32 v241, v241, v184
    v_mfma_f32_16x16x32_bf16 v[32:35], a[128:131], v[196:199], v[32:35]
    ds_read_b128 a[100:103], v209
    v_exp_f32 v179, v163
    v_mfma_f32_16x16x32_bf16 v[36:39], a[132:135], v[196:199], v[36:39]
    v_exp_f32 v180, v164
    v_mfma_f32_16x16x32_bf16 v[40:43], a[136:139], v[196:199], v[40:43]
    v_cvt_pk_bf16_f32 v192, v176, v177
    v_mfma_f32_16x16x32_bf16 v[44:47], a[140:143], v[196:199], v[44:47]
    v_exp_f32 v181, v165
    v_cvt_pk_bf16_f32 v193, v178, v179
    v_mfma_f32_16x16x32_bf16 v[48:51], a[144:147], v[196:199], v[48:51]
    ds_read_b128 a[104:107], v210
    v_exp_f32 v182, v166
    v_mfma_f32_16x16x32_bf16 v[52:55], a[148:151], v[196:199], v[52:55]
    v_exp_f32 v183, v167
    v_mfma_f32_16x16x32_bf16 v[56:59], a[152:155], v[196:199], v[56:59]
    s_waitcnt vmcnt(7)
    buffer_store_dwordx4 a[208:211], v234, s[16:19], s24 offen sc0 sc1 nt
    v_mfma_f32_16x16x32_bf16 v[60:63], a[156:159], v[196:199], v[60:63]
    v_cvt_pk_bf16_f32 v194, v180, v181
    v_cvt_pk_bf16_f32 v195, v182, v183
    v_mfma_f32_16x16x32_bf16 v[128:131], a[64:67], a[0:3], 0
    v_fma_f32 v168, v136, s33, v243
    v_fma_f32 v169, v137, s33, v243
    v_mfma_f32_16x16x32_bf16 v[176:179], a[216:219], v[192:195], 0
    ds_read_b128 a[108:111], v211
    v_fma_f32 v170, v138, s33, v243
    v_mfma_f32_16x16x32_bf16 v[128:131], a[68:71], a[4:7], v[128:131]
    v_exp_f32 v184, v168
    v_fma_f32 v171, v139, s33, v243
    v_mfma_f32_16x16x32_bf16 v[128:131], a[72:75], a[8:11], v[128:131]
    v_fma_f32 v172, v140, s33, v243
    v_mfma_f32_16x16x32_bf16 v[128:131], a[76:79], a[12:15], v[128:131]
    v_exp_f32 v185, v169
    v_cmp_nge_f32 vcc, s39, v176
    v_mfma_f32_16x16x32_bf16 v[132:135], a[80:83], a[0:3], 0
    ds_read_b128 a[112:115], v208 offset:4096
    v_fma_f32 v173, v141, s33, v243
    v_mfma_f32_16x16x32_bf16 v[132:135], a[84:87], a[4:7], v[132:135]
    s_mov_b32 m0, s30
    v_fma_f32 v174, v142, s33, v243
    v_exp_f32 v186, v170
    v_mfma_f32_16x16x32_bf16 v[132:135], a[88:91], a[8:11], v[132:135]
    s_waitcnt vmcnt(6)
    buffer_load_dwordx4 v229, s[4:7], s22 offen offset:1024 nt lds
    v_mfma_f32_16x16x32_bf16 v[132:135], a[92:95], a[12:15], v[132:135]
    s_cbranch_vccnz L_TRN1
L_RTN1:
    v_fma_f32 v175, v143, s33, v243
    v_add_f32 v238, v238, v176
    v_mfma_f32_16x16x32_bf16 v[136:139], a[64:67], a[16:19], 0
    v_exp_f32 v187, v171
    v_mfma_f32_16x16x32_bf16 v[136:139], a[68:71], a[20:23], v[136:139]
    ds_read_b128 a[116:119], v209 offset:4096
    v_exp_f32 v188, v172
    v_mfma_f32_16x16x32_bf16 v[136:139], a[72:75], a[24:27], v[136:139]
    ds_read_b128 a[212:215], v236 offset:4096
    v_mfma_f32_16x16x32_bf16 v[136:139], a[76:79], a[28:31], v[136:139]
    v_cvt_pk_bf16_f32 v196, v184, v185
    v_exp_f32 v189, v173
    v_mfma_f32_16x16x32_bf16 v[140:143], a[80:83], a[16:19], 0
    v_cvt_pk_bf16_f32 v197, v186, v187
    v_mfma_f32_16x16x32_bf16 v[140:143], a[84:87], a[20:23], v[140:143]
    v_exp_f32 v190, v174
    v_mfma_f32_16x16x32_bf16 v[140:143], a[88:91], a[24:27], v[140:143]
    ds_read_b128 a[120:123], v210 offset:4096
    v_exp_f32 v191, v175
    v_mfma_f32_16x16x32_bf16 v[140:143], a[92:95], a[28:31], v[140:143]
    v_cvt_pk_bf16_f32 v198, v188, v189
    v_cvt_pk_bf16_f32 v199, v190, v191
    v_mfma_f32_16x16x32_bf16 v[64:67], a[128:131], v[200:203], v[64:67]
    v_fma_f32 v160, v144, s33, v244
    v_fma_f32 v161, v145, s33, v244
    v_fma_f32 v162, v146, s33, v244
    v_mfma_f32_16x16x32_bf16 v[184:187], a[216:219], v[196:199], 0
    v_exp_f32 v176, v160
    v_mfma_f32_16x16x32_bf16 v[68:71], a[132:135], v[200:203], v[68:71]
    ds_read_b128 a[124:127], v211 offset:4096
    v_fma_f32 v163, v147, s33, v244
    v_fma_f32 v164, v148, s33, v244
    v_mfma_f32_16x16x32_bf16 v[72:75], a[136:139], v[200:203], v[72:75]
    v_exp_f32 v177, v161
    v_mfma_f32_16x16x32_bf16 v[76:79], a[140:143], v[200:203], v[76:79]
    v_fma_f32 v165, v149, s33, v244
    v_fma_f32 v166, v150, s33, v244
    v_cmp_nge_f32 vcc, s39, v184
    v_mfma_f32_16x16x32_bf16 v[80:83], a[144:147], v[200:203], v[80:83]
    v_exp_f32 v178, v162
    v_mfma_f32_16x16x32_bf16 v[84:87], a[148:151], v[200:203], v[84:87]
    s_mov_b32 m0, s30
    v_fma_f32 v167, v151, s33, v244
    v_exp_f32 v179, v163
    v_mfma_f32_16x16x32_bf16 v[88:91], a[152:155], v[200:203], v[88:91]
    s_waitcnt vmcnt(5)
    buffer_load_dwordx4 v230, s[4:7], s22 offen offset:2048 nt lds
    v_mfma_f32_16x16x32_bf16 v[92:95], a[156:159], v[200:203], v[92:95]
    s_cbranch_vccnz L_TRN2
L_RTN2:
    v_exp_f32 v180, v164
    v_add_f32 v239, v239, v184
    v_mfma_f32_16x16x32_bf16 v[96:99], a[128:131], v[204:207], v[96:99]
    ds_read_b64_tr_b16 a[128:129], v212 offset:16384
    v_cvt_pk_bf16_f32 v200, v176, v177
    v_mfma_f32_16x16x32_bf16 v[100:103], a[132:135], v[204:207], v[100:103]
    ds_read_b64_tr_b16 a[130:131], v212 offset:20480
    v_exp_f32 v181, v165
    v_mfma_f32_16x16x32_bf16 v[104:107], a[136:139], v[204:207], v[104:107]
    ds_read_b64_tr_b16 a[132:133], v213 offset:16384
    v_cvt_pk_bf16_f32 v201, v178, v179
    v_mfma_f32_16x16x32_bf16 v[108:111], a[140:143], v[204:207], v[108:111]
    ds_read_b64_tr_b16 a[134:135], v213 offset:20480
    v_exp_f32 v182, v166
    v_mfma_f32_16x16x32_bf16 v[112:115], a[144:147], v[204:207], v[112:115]
    ds_read_b64_tr_b16 a[136:137], v214 offset:16384
    v_exp_f32 v183, v167
    v_mfma_f32_16x16x32_bf16 v[116:119], a[148:151], v[204:207], v[116:119]
    s_add_u32 m0, s25, 0
    ds_read_b64_tr_b16 a[138:139], v214 offset:20480
    v_cvt_pk_bf16_f32 v202, v180, v181
    v_mfma_f32_16x16x32_bf16 v[120:123], a[152:155], v[204:207], v[120:123]
    s_waitcnt vmcnt(4)
    buffer_load_dwordx4 v234, s[12:15], s24 offen nt lds
    v_mfma_f32_16x16x32_bf16 v[124:127], a[156:159], v[204:207], v[124:127]
    ds_read_b64_tr_b16 a[140:141], v215 offset:16384
    v_cvt_pk_bf16_f32 v203, v182, v183
    v_mfma_f32_16x16x32_bf16 v[144:147], a[64:67], a[32:35], 0
    ds_read_b64_tr_b16 a[142:143], v215 offset:20480
    v_fma_f32 v168, v152, s33, v245
    v_fma_f32 v169, v153, s33, v245
    v_mfma_f32_16x16x32_bf16 v[176:179], a[216:219], v[200:203], 0
    ds_read_b64_tr_b16 a[144:145], v216 offset:16384
    v_fma_f32 v170, v154, s33, v245
    v_mfma_f32_16x16x32_bf16 v[144:147], a[68:71], a[36:39], v[144:147]
    ds_read_b64_tr_b16 a[146:147], v216 offset:20480
    v_exp_f32 v184, v168
    v_mfma_f32_16x16x32_bf16 v[144:147], a[72:75], a[40:43], v[144:147]
    ds_read_b64_tr_b16 a[148:149], v217 offset:16384
    v_xor_b32 v234, 128, v234
    v_mfma_f32_16x16x32_bf16 v[144:147], a[76:79], a[44:47], v[144:147]
    ds_read_b64_tr_b16 a[150:151], v217 offset:20480
    v_fma_f32 v171, v155, s33, v245
    v_cmp_nge_f32 vcc, s39, v176
    v_mfma_f32_16x16x32_bf16 v[148:151], a[80:83], a[32:35], 0
    ds_read_b64_tr_b16 a[152:153], v218 offset:16384
    v_fma_f32 v172, v156, s33, v245
    v_mfma_f32_16x16x32_bf16 v[148:151], a[84:87], a[36:39], v[148:151]
    s_mov_b32 m0, s30
    ds_read_b64_tr_b16 a[154:155], v218 offset:20480
    v_exp_f32 v185, v169
    v_mfma_f32_16x16x32_bf16 v[148:151], a[88:91], a[40:43], v[148:151]
    s_waitcnt vmcnt(3)
    buffer_load_dwordx4 v231, s[4:7], s22 offen offset:3072 nt lds
    v_mfma_f32_16x16x32_bf16 v[148:151], a[92:95], a[44:47], v[148:151]
    s_cbranch_vccnz L_TRN3
L_RTN3:
    ds_read_b64_tr_b16 a[156:157], v219 offset:16384
    v_add_f32 v240, v240, v176
    v_mfma_f32_16x16x32_bf16 v[152:155], a[64:67], a[48:51], 0
    s_mov_b32 s36, s22
    ds_read_b64_tr_b16 a[158:159], v219 offset:20480
    v_fma_f32 v173, v157, s33, v245
    v_fma_f32 v174, v158, s33, v245
    v_mfma_f32_16x16x32_bf16 v[152:155], a[68:71], a[52:55], v[152:155]
    s_add_u32 s22, s22, 4096
    v_exp_f32 v186, v170
    v_fma_f32 v175, v159, s33, v245
    v_mfma_f32_16x16x32_bf16 v[152:155], a[72:75], a[56:59], v[152:155]
    s_and_b32 s35, s22, 28672
    v_exp_f32 v187, v171
    v_mfma_f32_16x16x32_bf16 v[152:155], a[76:79], a[60:63], v[152:155]
    s_cselect_b32 s35, 0, 0x1ff8000
    v_exp_f32 v188, v172
    v_cvt_pk_bf16_f32 v204, v184, v185
    v_mfma_f32_16x16x32_bf16 v[156:159], a[80:83], a[48:51], 0
    s_add_u32 s22, s22, s35
    v_exp_f32 v189, v173
    v_mfma_f32_16x16x32_bf16 v[156:159], a[84:87], a[52:55], v[156:159]
    v_cvt_pk_bf16_f32 v205, v186, v187
    v_exp_f32 v190, v174
    v_mfma_f32_16x16x32_bf16 v[156:159], a[88:91], a[56:59], v[156:159]
    s_cmp_eq_u32 s29, 65536
    v_exp_f32 v191, v175
    v_mfma_f32_16x16x32_bf16 v[156:159], a[92:95], a[60:63], v[156:159]
    s_waitcnt lgkmcnt(2)
    s_cselect_b32 s31, 0xffff0000, s38
    v_cvt_pk_bf16_f32 v206, v188, v189
    v_cvt_pk_bf16_f32 v207, v190, v191
    v_mfma_f32_16x16x32_bf16 v[0:3], a[128:131], v[192:195], v[0:3]
    v_fma_f32 v160, v128, s33, v242
    v_fma_f32 v161, v129, s33, v242
    v_mfma_f32_16x16x32_bf16 v[184:187], a[216:219], v[204:207], 0
    v_fma_f32 v162, v130, s33, v242
    v_exp_f32 v176, v160
    v_mfma_f32_16x16x32_bf16 v[4:7], a[132:135], v[192:195], v[4:7]
    v_fma_f32 v163, v131, s33, v242
    v_fma_f32 v164, v132, s33, v242
    v_mfma_f32_16x16x32_bf16 v[8:11], a[136:139], v[192:195], v[8:11]
    v_exp_f32 v177, v161
    v_mfma_f32_16x16x32_bf16 v[12:15], a[140:143], v[192:195], v[12:15]
    ds_read_b128 a[64:67], v208 offset:8192
    v_cmp_nge_f32 vcc, s39, v184
    v_mfma_f32_16x16x32_bf16 v[16:19], a[144:147], v[192:195], v[16:19]
    v_fma_f32 v165, v133, s33, v242
    v_fma_f32 v166, v134, s33, v242
    v_mfma_f32_16x16x32_bf16 v[20:23], a[148:151], v[192:195], v[20:23]
    s_add_u32 m0, s30, 16384
    v_exp_f32 v178, v162
    v_fma_f32 v167, v135, s33, v242
    v_mfma_f32_16x16x32_bf16 v[24:27], a[152:155], v[192:195], v[24:27]
    s_waitcnt vmcnt(3) lgkmcnt(1)
    buffer_load_dwordx4 v232, s[8:11], s23 offen nt lds
    v_mfma_f32_16x16x32_bf16 v[28:31], a[156:159], v[192:195], v[28:31]
    s_cbranch_vccnz L_TRN4
L_RTN4:
    v_exp_f32 v179, v163
    v_add_f32 v241, v241, v184
    v_mfma_f32_16x16x32_bf16 v[32:35], a[128:131], v[196:199], v[32:35]
    ds_read_b128 a[68:71], v209 offset:8192
    v_mfma_f32_16x16x32_bf16 v[36:39], a[132:135], v[196:199], v[36:39]
    v_exp_f32 v180, v164
    v_cvt_pk_bf16_f32 v192, v176, v177
    v_mfma_f32_16x16x32_bf16 v[40:43], a[136:139], v[196:199], v[40:43]
    v_exp_f32 v181, v165
    v_mfma_f32_16x16x32_bf16 v[44:47], a[140:143], v[196:199], v[44:47]
    v_cvt_pk_bf16_f32 v193, v178, v179
    v_exp_f32 v182, v166
    v_mfma_f32_16x16x32_bf16 v[48:51], a[144:147], v[196:199], v[48:51]
    ds_read_b128 a[72:75], v210 offset:8192
    v_mfma_f32_16x16x32_bf16 v[52:55], a[148:151], v[196:199], v[52:55]
    v_exp_f32 v183, v167
    v_cvt_pk_bf16_f32 v194, v180, v181
    v_mfma_f32_16x16x32_bf16 v[56:59], a[152:155], v[196:199], v[56:59]
    s_waitcnt vmcnt(3)
    buffer_store_dwordx4 a[212:215], v235, s[80:83], s24 offen offset:1024 sc0 sc1 nt
    v_mfma_f32_16x16x32_bf16 v[60:63], a[156:159], v[196:199], v[60:63]
    v_cvt_pk_bf16_f32 v195, v182, v183
    v_mfma_f32_16x16x32_bf16 v[128:131], a[96:99], a[0:3], 0
    v_fma_f32 v168, v136, s33, v243
    v_fma_f32 v169, v137, s33, v243
    v_mfma_f32_16x16x32_bf16 v[176:179], a[216:219], v[192:195], 0
    ds_read_b128 a[76:79], v211 offset:8192
    v_fma_f32 v170, v138, s33, v243
    v_mfma_f32_16x16x32_bf16 v[128:131], a[100:103], a[4:7], v[128:131]
    v_exp_f32 v184, v168
    v_fma_f32 v171, v139, s33, v243
    v_mfma_f32_16x16x32_bf16 v[128:131], a[104:107], a[8:11], v[128:131]
    v_fma_f32 v172, v140, s33, v243
    v_exp_f32 v185, v169
    v_mfma_f32_16x16x32_bf16 v[128:131], a[108:111], a[12:15], v[128:131]
    v_fma_f32 v173, v141, s33, v243
    v_cmp_nge_f32 vcc, s39, v176
    v_mfma_f32_16x16x32_bf16 v[132:135], a[112:115], a[0:3], 0
    ds_read_b128 a[80:83], v208 offset:12288
    v_fma_f32 v174, v142, s33, v243
    v_mfma_f32_16x16x32_bf16 v[132:135], a[116:119], a[4:7], v[132:135]
    s_add_u32 m0, s30, 16384
    v_exp_f32 v186, v170
    v_add_u32 v208, s31, v208
    v_mfma_f32_16x16x32_bf16 v[132:135], a[120:123], a[8:11], v[132:135]
    s_waitcnt vmcnt(3)
    buffer_load_dwordx4 v233, s[8:11], s23 offen offset:1024 nt lds
    v_mfma_f32_16x16x32_bf16 v[132:135], a[124:127], a[12:15], v[132:135]
    s_cbranch_vccnz L_TRN5
L_RTN5:
    v_fma_f32 v175, v143, s33, v243
    v_add_f32 v238, v238, v176
    v_mfma_f32_16x16x32_bf16 v[136:139], a[96:99], a[16:19], 0
    v_exp_f32 v187, v171
    v_exp_f32 v188, v172
    v_mfma_f32_16x16x32_bf16 v[136:139], a[100:103], a[20:23], v[136:139]
    ds_read_b128 a[84:87], v209 offset:12288
    v_cvt_pk_bf16_f32 v196, v184, v185
    v_mfma_f32_16x16x32_bf16 v[136:139], a[104:107], a[24:27], v[136:139]
    ds_read_b128 a[208:211], v236 offset:8192
    v_add_u32 v209, s31, v209
    v_mfma_f32_16x16x32_bf16 v[136:139], a[108:111], a[28:31], v[136:139]
    v_exp_f32 v189, v173
    v_mfma_f32_16x16x32_bf16 v[140:143], a[112:115], a[16:19], 0
    v_cvt_pk_bf16_f32 v197, v186, v187
    v_exp_f32 v190, v174
    v_mfma_f32_16x16x32_bf16 v[140:143], a[116:119], a[20:23], v[140:143]
    v_exp_f32 v191, v175
    v_mfma_f32_16x16x32_bf16 v[140:143], a[120:123], a[24:27], v[140:143]
    ds_read_b128 a[88:91], v210 offset:12288
    v_cvt_pk_bf16_f32 v198, v188, v189
    v_add_u32 v236, 8192, v236
    v_mfma_f32_16x16x32_bf16 v[140:143], a[124:127], a[28:31], v[140:143]
    v_cvt_pk_bf16_f32 v199, v190, v191
    v_add_u32 v210, s31, v210
    v_mfma_f32_16x16x32_bf16 v[64:67], a[128:131], v[200:203], v[64:67]
    v_fma_f32 v160, v144, s33, v244
    v_fma_f32 v161, v145, s33, v244
    v_fma_f32 v162, v146, s33, v244
    v_mfma_f32_16x16x32_bf16 v[184:187], a[216:219], v[196:199], 0
    v_exp_f32 v176, v160
    v_fma_f32 v163, v147, s33, v244
    v_mfma_f32_16x16x32_bf16 v[68:71], a[132:135], v[200:203], v[68:71]
    ds_read_b128 a[92:95], v211 offset:12288
    v_fma_f32 v164, v148, s33, v244
    v_mfma_f32_16x16x32_bf16 v[72:75], a[136:139], v[200:203], v[72:75]
    v_exp_f32 v177, v161
    v_add_u32 v211, s31, v211
    v_mfma_f32_16x16x32_bf16 v[76:79], a[140:143], v[200:203], v[76:79]
    v_fma_f32 v165, v149, s33, v244
    v_fma_f32 v166, v150, s33, v244
    v_cmp_nge_f32 vcc, s39, v184
    v_mfma_f32_16x16x32_bf16 v[80:83], a[144:147], v[200:203], v[80:83]
    v_exp_f32 v178, v162
    v_fma_f32 v167, v151, s33, v244
    v_mfma_f32_16x16x32_bf16 v[84:87], a[148:151], v[200:203], v[84:87]
    s_add_u32 m0, s30, 16384
    v_exp_f32 v179, v163
    v_mfma_f32_16x16x32_bf16 v[88:91], a[152:155], v[200:203], v[88:91]
    s_waitcnt vmcnt(3)
    buffer_load_dwordx4 v232, s[8:11], s23 offen offset:2048 nt lds
    v_mfma_f32_16x16x32_bf16 v[92:95], a[156:159], v[200:203], v[92:95]
    s_cbranch_vccnz L_TRN6
L_RTN6:
    v_exp_f32 v180, v164
    v_add_f32 v239, v239, v184
    v_mfma_f32_16x16x32_bf16 v[96:99], a[128:131], v[204:207], v[96:99]
    s_add_u32 s20, s20, 1
    ds_read_b64_tr_b16 a[128:129], v212 offset:24576
    v_cvt_pk_bf16_f32 v200, v176, v177
    v_mfma_f32_16x16x32_bf16 v[100:103], a[132:135], v[204:207], v[100:103]
    ds_read_b64_tr_b16 a[130:131], v212 offset:28672
    v_exp_f32 v181, v165
    v_cvt_pk_bf16_f32 v201, v178, v179
    v_mfma_f32_16x16x32_bf16 v[104:107], a[136:139], v[204:207], v[104:107]
    s_and_b32 s21, s20, 7
    ds_read_b64_tr_b16 a[132:133], v213 offset:24576
    v_add_u32 v212, s31, v212
    v_mfma_f32_16x16x32_bf16 v[108:111], a[140:143], v[204:207], v[108:111]
    ds_read_b64_tr_b16 a[134:135], v213 offset:28672
    v_exp_f32 v182, v166
    v_mfma_f32_16x16x32_bf16 v[112:115], a[144:147], v[204:207], v[112:115]
    ds_read_b64_tr_b16 a[136:137], v214 offset:24576
    v_add_u32 v213, s31, v213
    v_mfma_f32_16x16x32_bf16 v[116:119], a[148:151], v[204:207], v[116:119]
    s_add_u32 m0, s25, 3072
    ds_read_b64_tr_b16 a[138:139], v214 offset:28672
    v_exp_f32 v183, v167
    v_cvt_pk_bf16_f32 v202, v180, v181
    v_mfma_f32_16x16x32_bf16 v[120:123], a[152:155], v[204:207], v[120:123]
    s_waitcnt vmcnt(3)
    buffer_load_dwordx4 v235, s[12:15], s24 offen offset:1024 nt lds
    v_add_u32 v214, s31, v214
    v_mfma_f32_16x16x32_bf16 v[124:127], a[156:159], v[204:207], v[124:127]
    ds_read_b64_tr_b16 a[140:141], v215 offset:24576
    v_cvt_pk_bf16_f32 v203, v182, v183
    v_mfma_f32_16x16x32_bf16 v[144:147], a[96:99], a[32:35], 0
    s_add_u32 s28, s28, 2048
    ds_read_b64_tr_b16 a[142:143], v215 offset:28672
    v_fma_f32 v168, v152, s33, v245
    v_fma_f32 v169, v153, s33, v245
    v_mfma_f32_16x16x32_bf16 v[176:179], a[216:219], v[200:203], 0
    s_add_u32 s25, s25, 8192
    ds_read_b64_tr_b16 a[144:145], v216 offset:24576
    v_fma_f32 v170, v154, s33, v245
    v_add_u32 v215, s31, v215
    v_mfma_f32_16x16x32_bf16 v[144:147], a[100:103], a[36:39], v[144:147]
    s_xor_b32 s24, s28, s27
    ds_read_b64_tr_b16 a[146:147], v216 offset:28672
    v_exp_f32 v184, v168
    v_mfma_f32_16x16x32_bf16 v[144:147], a[104:107], a[40:43], v[144:147]
    ds_read_b64_tr_b16 a[148:149], v217 offset:24576
    v_xor_b32 v235, 128, v235
    v_add_u32 v216, s31, v216
    v_mfma_f32_16x16x32_bf16 v[144:147], a[108:111], a[44:47], v[144:147]
    ds_read_b64_tr_b16 a[150:151], v217 offset:28672
    v_cmp_nge_f32 vcc, s39, v176
    v_mfma_f32_16x16x32_bf16 v[148:151], a[112:115], a[32:35], 0
    ds_read_b64_tr_b16 a[152:153], v218 offset:24576
    v_fma_f32 v171, v155, s33, v245
    v_add_u32 v217, s31, v217
    v_mfma_f32_16x16x32_bf16 v[148:151], a[116:119], a[36:39], v[148:151]
    s_add_u32 m0, s30, 16384
    ds_read_b64_tr_b16 a[154:155], v218 offset:28672
    v_fma_f32 v172, v156, s33, v245
    v_mfma_f32_16x16x32_bf16 v[148:151], a[120:123], a[40:43], v[148:151]
    s_waitcnt vmcnt(3)
    buffer_load_dwordx4 v233, s[8:11], s23 offen offset:3072 nt lds
    v_add_u32 v218, s31, v218
    v_mfma_f32_16x16x32_bf16 v[148:151], a[124:127], a[44:47], v[148:151]
    s_add_u32 s30, s29, s32
    ds_read_b64_tr_b16 a[156:157], v219 offset:24576
    v_exp_f32 v185, v169
    v_mfma_f32_16x16x32_bf16 v[152:155], a[96:99], a[48:51], 0
    s_mov_b32 s23, s36
    ds_read_b64_tr_b16 a[158:159], v219 offset:28672
    v_fma_f32 v173, v157, s33, v245
    v_fma_f32 v174, v158, s33, v245
    v_mfma_f32_16x16x32_bf16 v[152:155], a[100:103], a[52:55], v[152:155]
    s_add_u32 s29, s29, s31
    v_exp_f32 v186, v170
    v_add_u32 v219, s31, v219
    v_mfma_f32_16x16x32_bf16 v[152:155], a[104:107], a[56:59], v[152:155]
    s_cbranch_vccnz L_TRN7
L_RTN7:
    v_fma_f32 v175, v159, s33, v245
    v_add_f32 v240, v240, v176
    v_mfma_f32_16x16x32_bf16 v[152:155], a[108:111], a[60:63], v[152:155]
    v_exp_f32 v187, v171
    v_exp_f32 v188, v172
    v_mfma_f32_16x16x32_bf16 v[156:159], a[112:115], a[48:51], 0
    v_cvt_pk_bf16_f32 v204, v184, v185
    v_exp_f32 v189, v173
    v_mfma_f32_16x16x32_bf16 v[156:159], a[116:119], a[52:55], v[156:159]
    v_cvt_pk_bf16_f32 v205, v186, v187
    v_mfma_f32_16x16x32_bf16 v[156:159], a[120:123], a[56:59], v[156:159]
    s_waitcnt vmcnt(10)
    v_exp_f32 v190, v174
    v_exp_f32 v191, v175
    v_mfma_f32_16x16x32_bf16 v[156:159], a[124:127], a[60:63], v[156:159]
    s_waitcnt lgkmcnt(2)
    s_cmp_lg_u32 s21, 2
    v_cvt_pk_bf16_f32 v206, v188, v189
    v_cvt_pk_bf16_f32 v207, v190, v191
    s_cbranch_scc1 L_TOPN
    s_branch L_SEL
L_DEFE:
    s_cmp_eq_u32 s20, 16
    s_cbranch_scc1 L_DEFE1
    ds_read_b128 a[160:163], v237 offset:20480
    ds_read_b128 a[164:167], v237 offset:28672
    ds_read_b128 a[168:171], v237 offset:36864
    ds_read_b128 a[172:175], v237 offset:45056
    ds_read_b128 a[176:179], v237 offset:53248
    ds_read_b128 a[180:183], v237 offset:61440
    s_branch L_DEFRETE
L_DEFE1:
    ds_read_b128 a[220:223], v237 offset:20480
    ds_read_b128 a[224:227], v237 offset:28672
    ds_read_b128 a[228:231], v237 offset:36864
    ds_read_b128 a[232:235], v237 offset:45056
    ds_read_b128 a[236:239], v237 offset:53248
    ds_read_b128 a[240:243], v237 offset:61440
    s_branch L_DEFRETE
L_DEFL:
    s_mov_b32 s35, 4096
    buffer_store_dwordx4 a[220:223], v229, s[76:79], s35 offen offset:1024 sc0 sc1 nt
    buffer_store_dwordx4 a[224:227], v231, s[76:79], s35 offen offset:3072 sc0 sc1 nt
    s_mov_b32 s35, 8192
    buffer_store_dwordx4 a[228:231], v229, s[76:79], s35 offen offset:1024 sc0 sc1 nt
    buffer_store_dwordx4 a[232:235], v231, s[76:79], s35 offen offset:3072 sc0 sc1 nt
    s_mov_b32 s35, 12288
    buffer_store_dwordx4 a[236:239], v229, s[76:79], s35 offen offset:1024 sc0 sc1 nt
    buffer_store_dwordx4 a[240:243], v231, s[76:79], s35 offen offset:3072 sc0 sc1 nt
    s_branch L_DEFRETL
L_TRE0:
    s_call_b64 s[68:69], L_FIX11
    s_branch L_RTE0
L_TRE5:
    s_call_b64 s[68:69], L_FIX00
    s_branch L_RTE5
L_TRE6:
    s_call_b64 s[68:69], L_FIX01
    s_branch L_RTE6
L_TRE7:
    s_call_b64 s[68:69], L_FIX10
    s_branch L_RTE7
L_TRM0:
    s_call_b64 s[68:69], L_FIX11
    s_branch L_RTM0
L_TRM1:
    s_call_b64 s[68:69], L_FIX00
    s_branch L_RTM1
L_TRM2:
    s_call_b64 s[68:69], L_FIX01
    s_branch L_RTM2
L_TRM3:
    s_call_b64 s[68:69], L_FIX10
    s_branch L_RTM3
L_TRM4:
    s_call_b64 s[68:69], L_FIX11
    s_branch L_RTM4
L_TRM5:
    s_call_b64 s[68:69], L_FIX00
    s_branch L_RTM5
L_TRM6:
    s_call_b64 s[68:69], L_FIX01
    s_branch L_RTM6
L_TRM7:
    s_call_b64 s[68:69], L_FIX10
    s_branch L_RTM7
L_TRZ0:
    s_call_b64 s[68:69], L_FIX11
    s_branch L_RTZ0
L_TRZ1:
    s_call_b64 s[68:69], L_FIX00
    s_branch L_RTZ1
L_TRZ2:
    s_call_b64 s[68:69], L_FIX01
    s_branch L_RTZ2
L_TRZ3:
    s_call_b64 s[68:69], L_FIX10
    s_branch L_RTZ3
L_TRZ4:
    s_call_b64 s[68:69], L_FIX11
    s_branch L_RTZ4
L_TRZ5:
    s_call_b64 s[68:69], L_FIX00
    s_branch L_RTZ5
L_TRZ6:
    s_call_b64 s[68:69], L_FIX01
    s_branch L_RTZ6
L_TRZ7:
    s_call_b64 s[68:69], L_FIX10
    s_branch L_RTZ7
L_TRL0:
    s_call_b64 s[68:69], L_FIX11
    s_branch L_RTL0
L_TRL1:
    s_call_b64 s[68:69], L_FIX00
    s_branch L_RTL1
L_TRL2:
    s_call_b64 s[68:69], L_FIX01
    s_branch L_RTL2
L_TRL3:
    s_call_b64 s[68:69], L_FIX10
    s_branch L_RTL3
L_TRL4:
    s_call_b64 s[68:69], L_FIX11
    s_branch L_RTL4
L_TRL5:
    s_call_b64 s[68:69], L_FIX00
    s_branch L_RTL5
L_TRL6:
    s_call_b64 s[68:69], L_FIX01
    s_branch L_RTL6
L_TRL7:
    s_call_b64 s[68:69], L_FIX10
    s_branch L_RTL7
L_TRF0:
    s_call_b64 s[68:69], L_FIX11
    s_branch L_RTF0
L_TRF1:
    s_call_b64 s[68:69], L_FIX00
    s_branch L_RTF1
L_TRF2:
    s_call_b64 s[68:69], L_FIX01
    s_branch L_RTF2
L_TRF3:
    s_call_b64 s[68:69], L_FIX10
    s_branch L_RTF3
L_TRF4:
    s_call_b64 s[68:69], L_FIX11
    s_branch L_RTF4
L_TRF5:
    s_call_b64 s[68:69], L_FIX00
    s_branch L_RTF5
L_TRF6:
    s_call_b64 s[68:69], L_FIX01
    s_branch L_RTF6
L_TRT0:
    s_call_b64 s[68:69], L_FIX10
    s_branch L_RTT0
L_TRT1:
    s_call_b64 s[68:69], L_FIX11
    s_branch L_RTT1
L_TRN0:
    s_call_b64 s[68:69], L_FIX11
    s_branch L_RTN0
L_TRN1:
    s_call_b64 s[68:69], L_FIX00
    s_branch L_RTN1
L_TRN2:
    s_call_b64 s[68:69], L_FIX01
    s_branch L_RTN2
L_TRN3:
    s_call_b64 s[68:69], L_FIX10
    s_branch L_RTN3
L_TRN4:
    s_call_b64 s[68:69], L_FIX11
    s_branch L_RTN4
L_TRN5:
    s_call_b64 s[68:69], L_FIX00
    s_branch L_RTN5
L_TRN6:
    s_call_b64 s[68:69], L_FIX01
    s_branch L_RTN6
L_TRN7:
    s_call_b64 s[68:69], L_FIX10
    s_branch L_RTN7
L_FIX00:
    v_max3_f32 v250, v160, v161, v162
    v_max3_f32 v250, v250, v163, v164
    v_max3_f32 v250, v250, v165, v166
    v_max_f32 v250, v250, v167
    v_mov_b32 v251, v250
    s_nop 1
    v_permlane32_swap_b32 v250, v251
    v_max_f32 v250, v250, v251
    v_mov_b32 v251, v250
    s_nop 1
    v_permlane16_swap_b32 v250, v251
    v_max_f32 v250, v250, v251
    v_max_f32 v250, 0, v250
    v_sub_f32 v242, v242, v250
    v_exp_f32_e64 v251, -v250
    v_sub_f32 v160, v160, v250
    v_sub_f32 v161, v161, v250
    v_sub_f32 v162, v162, v250
    v_sub_f32 v163, v163, v250
    v_sub_f32 v164, v164, v250
    v_sub_f32 v165, v165, v250
    v_sub_f32 v166, v166, v250
    v_sub_f32 v167, v167, v250
    v_exp_f32 v176, v160
    v_exp_f32 v177, v161
    v_exp_f32 v178, v162
    v_exp_f32 v179, v163
    v_exp_f32 v180, v164
    v_exp_f32 v181, v165
    v_exp_f32 v182, v166
    v_exp_f32 v183, v167
    v_cvt_pk_bf16_f32 v192, v176, v177
    v_cvt_pk_bf16_f32 v193, v178, v179
    v_cvt_pk_bf16_f32 v194, v180, v181
    v_cvt_pk_bf16_f32 v195, v182, v183
    v_mul_f32 v238, v238, v251
    v_mul_f32 v0, v0, v251
    v_mfma_f32_16x16x32_bf16 v[176:179], a[216:219], v[192:195], 0
    v_mul_f32 v1, v1, v251
    v_mul_f32 v2, v2, v251
    v_mul_f32 v3, v3, v251
    v_mul_f32 v4, v4, v251
    v_mul_f32 v5, v5, v251
    v_mul_f32 v6, v6, v251
    v_mul_f32 v7, v7, v251
    v_mul_f32 v8, v8, v251
    v_mul_f32 v9, v9, v251
    v_mul_f32 v10, v10, v251
    v_mul_f32 v11, v11, v251
    v_mul_f32 v12, v12, v251
    v_mul_f32 v13, v13, v251
    v_mul_f32 v14, v14, v251
    v_mul_f32 v15, v15, v251
    v_mul_f32 v16, v16, v251
    v_mul_f32 v17, v17, v251
    v_mul_f32 v18, v18, v251
    v_mul_f32 v19, v19, v251
    v_mul_f32 v20, v20, v251
    v_mul_f32 v21, v21, v251
    v_mul_f32 v22, v22, v251
    v_mul_f32 v23, v23, v251
    v_mul_f32 v24, v24, v251
    v_mul_f32 v25, v25, v251
    v_mul_f32 v26, v26, v251
    v_mul_f32 v27, v27, v251
    v_mul_f32 v28, v28, v251
    v_mul_f32 v29, v29, v251
    v_mul_f32 v30, v30, v251
    v_mul_f32 v31, v31, v251
    s_setpc_b64 s[68:69]
L_FIX01:
    v_max3_f32 v250, v168, v169, v170
    v_max3_f32 v250, v250, v171, v172
    v_max3_f32 v250, v250, v173, v174
    v_max_f32 v250, v250, v175
    v_mov_b32 v251, v250
    s_nop 1
    v_permlane32_swap_b32 v250, v251
    v_max_f32 v250, v250, v251
    v_mov_b32 v251, v250
    s_nop 1
    v_permlane16_swap_b32 v250, v251
    v_max_f32 v250, v250, v251
    v_max_f32 v250, 0, v250
    v_sub_f32 v243, v243, v250
    v_exp_f32_e64 v251, -v250
    v_sub_f32 v168, v168, v250
    v_sub_f32 v169, v169, v250
    v_sub_f32 v170, v170, v250
    v_sub_f32 v171, v171, v250
    v_sub_f32 v172, v172, v250
    v_sub_f32 v173, v173, v250
    v_sub_f32 v174, v174, v250
    v_sub_f32 v175, v175, v250
    v_exp_f32 v184, v168
    v_exp_f32 v185, v169
    v_exp_f32 v186, v170
    v_exp_f32 v187, v171
    v_exp_f32 v188, v172
    v_exp_f32 v189, v173
    v_exp_f32 v190, v174
    v_exp_f32 v191, v175
    v_cvt_pk_bf16_f32 v196, v184, v185
    v_cvt_pk_bf16_f32 v197, v186, v187
    v_cvt_pk_bf16_f32 v198, v188, v189
    v_cvt_pk_bf16_f32 v199, v190, v191
    v_mul_f32 v239, v239, v251
    v_mul_f32 v32, v32, v251
    v_mfma_f32_16x16x32_bf16 v[184:187], a[216:219], v[196:199], 0
    v_mul_f32 v33, v33, v251
    v_mul_f32 v34, v34, v251
    v_mul_f32 v35, v35, v251
    v_mul_f32 v36, v36, v251
    v_mul_f32 v37, v37, v251
    v_mul_f32 v38, v38, v251
    v_mul_f32 v39, v39, v251
    v_mul_f32 v40, v40, v251
    v_mul_f32 v41, v41, v251
    v_mul_f32 v42, v42, v251
    v_mul_f32 v43, v43, v251
    v_mul_f32 v44, v44, v251
    v_mul_f32 v45, v45, v251
    v_mul_f32 v46, v46, v251
    v_mul_f32 v47, v47, v251
    v_mul_f32 v48, v48, v251
    v_mul_f32 v49, v49, v251
    v_mul_f32 v50, v50, v251
    v_mul_f32 v51, v51, v251
    v_mul_f32 v52, v52, v251
    v_mul_f32 v53, v53, v251
    v_mul_f32 v54, v54, v251
    v_mul_f32 v55, v55, v251
    v_mul_f32 v56, v56, v251
    v_mul_f32 v57, v57, v251
    v_mul_f32 v58, v58, v251
    v_mul_f32 v59, v59, v251
    v_mul_f32 v60, v60, v251
    v_mul_f32 v61, v61, v251
    v_mul_f32 v62, v62, v251
    v_mul_f32 v63, v63, v251
    s_setpc_b64 s[68:69]
L_FIX10:
    v_max3_f32 v250, v160, v161, v162
    v_max3_f32 v250, v250, v163, v164
    v_max3_f32 v250, v250, v165, v166
    v_max_f32 v250, v250, v167
    v_mov_b32 v251, v250
    s_nop 1
    v_permlane32_swap_b32 v250, v251
    v_max_f32 v250, v250, v251
    v_mov_b32 v251, v250
    s_nop 1
    v_permlane16_swap_b32 v250, v251
    v_max_f32 v250, v250, v251
    v_max_f32 v250, 0, v250
    v_sub_f32 v244, v244, v250
    v_exp_f32_e64 v251, -v250
    v_sub_f32 v160, v160, v250
    v_sub_f32 v161, v161, v250
    v_sub_f32 v162, v162, v250
    v_sub_f32 v163, v163, v250
    v_sub_f32 v164, v164, v250
    v_sub_f32 v165, v165, v250
    v_sub_f32 v166, v166, v250
    v_sub_f32 v167, v167, v250
    v_exp_f32 v176, v160
    v_exp_f32 v177, v161
    v_exp_f32 v178, v162
    v_exp_f32 v179, v163
    v_exp_f32 v180, v164
    v_exp_f32 v181, v165
    v_exp_f32 v182, v166
    v_exp_f32 v183, v167
    v_cvt_pk_bf16_f32 v200, v176, v177
    v_cvt_pk_bf16_f32 v201, v178, v179
    v_cvt_pk_bf16_f32 v202, v180, v181
    v_cvt_pk_bf16_f32 v203, v182, v183
    v_mul_f32 v240, v240, v251
    v_mul_f32 v64, v64, v251
    v_mfma_f32_16x16x32_bf16 v[176:179], a[216:219], v[200:203], 0
    v_mul_f32 v65, v65, v251
    v_mul_f32 v66, v66, v251
    v_mul_f32 v67, v67, v251
    v_mul_f32 v68, v68, v251
    v_mul_f32 v69, v69, v251
    v_mul_f32 v70, v70, v251
    v_mul_f32 v71, v71, v251
    v_mul_f32 v72, v72, v251
    v_mul_f32 v73, v73, v251
    v_mul_f32 v74, v74, v251
    v_mul_f32 v75, v75, v251
    v_mul_f32 v76, v76, v251
    v_mul_f32 v77, v77, v251
    v_mul_f32 v78, v78, v251
    v_mul_f32 v79, v79, v251
    v_mul_f32 v80, v80, v251
    v_mul_f32 v81, v81, v251
    v_mul_f32 v82, v82, v251
    v_mul_f32 v83, v83, v251
    v_mul_f32 v84, v84, v251
    v_mul_f32 v85, v85, v251
    v_mul_f32 v86, v86, v251
    v_mul_f32 v87, v87, v251
    v_mul_f32 v88, v88, v251
    v_mul_f32 v89, v89, v251
    v_mul_f32 v90, v90, v251
    v_mul_f32 v91, v91, v251
    v_mul_f32 v92, v92, v251
    v_mul_f32 v93, v93, v251
    v_mul_f32 v94, v94, v251
    v_mul_f32 v95, v95, v251
    s_setpc_b64 s[68:69]
L_FIX11:
    v_max3_f32 v250, v168, v169, v170
    v_max3_f32 v250, v250, v171, v172
    v_max3_f32 v250, v250, v173, v174
    v_max_f32 v250, v250, v175
    v_mov_b32 v251, v250
    s_nop 1
    v_permlane32_swap_b32 v250, v251
    v_max_f32 v250, v250, v251
    v_mov_b32 v251, v250
    s_nop 1
    v_permlane16_swap_b32 v250, v251
    v_max_f32 v250, v250, v251
    v_max_f32 v250, 0, v250
    v_sub_f32 v245, v245, v250
    v_exp_f32_e64 v251, -v250
    v_sub_f32 v168, v168, v250
    v_sub_f32 v169, v169, v250
    v_sub_f32 v170, v170, v250
    v_sub_f32 v171, v171, v250
    v_sub_f32 v172, v172, v250
    v_sub_f32 v173, v173, v250
    v_sub_f32 v174, v174, v250
    v_sub_f32 v175, v175, v250
    v_exp_f32 v184, v168
    v_exp_f32 v185, v169
    v_exp_f32 v186, v170
    v_exp_f32 v187, v171
    v_exp_f32 v188, v172
    v_exp_f32 v189, v173
    v_exp_f32 v190, v174
    v_exp_f32 v191, v175
    v_cvt_pk_bf16_f32 v204, v184, v185
    v_cvt_pk_bf16_f32 v205, v186, v187
    v_cvt_pk_bf16_f32 v206, v188, v189
    v_cvt_pk_bf16_f32 v207, v190, v191
    v_mul_f32 v241, v241, v251
    v_mul_f32 v96, v96, v251
    v_mfma_f32_16x16x32_bf16 v[184:187], a[216:219], v[204:207], 0
    v_mul_f32 v97, v97, v251
    v_mul_f32 v98, v98, v251
    v_mul_f32 v99, v99, v251
    v_mul_f32 v100, v100, v251
    v_mul_f32 v101, v101, v251
    v_mul_f32 v102, v102, v251
    v_mul_f32 v103, v103, v251
    v_mul_f32 v104, v104, v251
    v_mul_f32 v105, v105, v251
    v_mul_f32 v106, v106, v251
    v_mul_f32 v107, v107, v251
    v_mul_f32 v108, v108, v251
    v_mul_f32 v109, v109, v251
    v_mul_f32 v110, v110, v251
    v_mul_f32 v111, v111, v251
    v_mul_f32 v112, v112, v251
    v_mul_f32 v113, v113, v251
    v_mul_f32 v114, v114, v251
    v_mul_f32 v115, v115, v251
    v_mul_f32 v116, v116, v251
    v_mul_f32 v117, v117, v251
    v_mul_f32 v118, v118, v251
    v_mul_f32 v119, v119, v251
    v_mul_f32 v120, v120, v251
    v_mul_f32 v121, v121, v251
    v_mul_f32 v122, v122, v251
    v_mul_f32 v123, v123, v251
    v_mul_f32 v124, v124, v251
    v_mul_f32 v125, v125, v251
    v_mul_f32 v126, v126, v251
    v_mul_f32 v127, v127, v251
    s_setpc_b64 s[68:69]
L_PAD:
.fill (32768 + 256 - (L_PAD - standalone__mha_softmax__near_ridge_kernel)) / 4, 4, 0xbf810000
.section .rodata,"a"
.p2align 6
.amdhsa_kernel standalone__mha_softmax__near_ridge_kernel
  .amdhsa_next_free_vgpr 508
  .amdhsa_next_free_sgpr 84
  .amdhsa_accum_offset 256
  .amdhsa_group_segment_fixed_size 0
  .amdhsa_kernarg_size 48
  .amdhsa_user_sgpr_count 2
  .amdhsa_user_sgpr_kernarg_segment_ptr 1
  .amdhsa_system_sgpr_workgroup_id_x 1
.end_amdhsa_kernel
```
